```python
import torch

def _softmax(x, axis=-1):
    return torch.softmax(x, dim=axis)
def _gelu(x):
    return torch.nn.functional.gelu(x, approximate="tanh")
def _silu(x):
    return torch.nn.functional.silu(x)
def _sigmoid(x):
    return torch.sigmoid(x)
def _layernorm(x, axis=-1, eps=1e-5):
    m = x.mean(dim=axis, keepdim=True)
    v = x.var(dim=axis, keepdim=True, unbiased=False)
    return (x - m) / torch.sqrt(v + eps)
def _scatter_add(tgt, idx, src, axis=0):
    return tgt.clone().index_add_(axis, idx, src)
def _segment_sum(src, seg, n):
    out = torch.zeros((n,) + src.shape[1:], dtype=src.dtype)
    return out.index_add_(0, seg, src)
def _pad(x, pw):
    flat = tuple(v for pair in reversed(pw) for v in pair)
    return torch.nn.functional.pad(x, flat)

kernel_name = 'gated_mix__softmax_full_mha__moe_arch_mod__prompt'

def setup_inputs():

    _w = (lambda a: (lambda t: t.to(torch.bfloat16) if t.is_floating_point() else t)(torch.as_tensor(a)))
    def _A_setup():
        B, S, D = 1, 2048, 448
        return {
            "x": _w((lambda *s: torch.randn(*s, dtype=torch.bfloat16) * 0.05)(B, S, D)),
            "wqkv": _w((lambda *s: torch.randn(*s, dtype=torch.bfloat16) * 1.6)(D, 3 * D)),
            "wo": _w((lambda *s: torch.randn(*s, dtype=torch.bfloat16) * 0.1)(D, D)),
        }
    _A_in = _A_setup()

    def _B_setup():
        B, S, D, F, C = 1, 2048, 448, 1792, 8
        return {
            "x": _w((lambda *s: torch.randn(*s, dtype=torch.bfloat16) * 0.05)(B, S, D)),
            "w_r": _w((lambda *s: torch.randn(*s, dtype=torch.bfloat16) * 3.2)(D)),
            "w_gate": _w((lambda *s: torch.randn(*s, dtype=torch.bfloat16) * 0.4)(D, F)),
            "w_up": _w((lambda *s: torch.randn(*s, dtype=torch.bfloat16) * 0.4)(D, F)),
            "w_down": _w((lambda *s: torch.randn(*s, dtype=torch.bfloat16) * 0.4)(F, D)),
        }
    _B_in = _B_setup()

    return {
        "A_x": _A_in["x"],
        "A_wqkv": _A_in["wqkv"],
        "A_wo": _A_in["wo"],
        "B_x": _B_in["x"],
        "B_w_r": _B_in["w_r"],
        "B_w_gate": _B_in["w_gate"],
        "B_w_up": _B_in["w_up"],
        "B_w_down": _B_in["w_down"],
        "gate_w": _w((lambda *s: torch.randn(*s, dtype=torch.bfloat16) * 0.05)(448) * 16.0),
    }

def reference(A_x, A_wqkv, A_wo, B_x, B_w_r, B_w_gate, B_w_up, B_w_down, gate_w):
    def _A_ref(x, wqkv, wo):
        B, S, D = x.shape
        H = 16; Dh = D // H
        qkv = (lambda x, *d: x.permute(*d))((x @ wqkv).reshape(B, S, 3, H, Dh), 2, 0, 3, 1, 4)
        q, k, v = qkv[0], qkv[1], qkv[2]
        scale = Dh ** -0.5
        scores = torch.einsum("bhqd,bhkd->bhqk", q, k) * scale
        p = _softmax(scores, axis=-1)
        o = torch.einsum("bhqk,bhkd->bhqd", p, v)
        return (lambda x, *d: x.permute(*d))(o, 0, 2, 1, 3).reshape(B, S, D) @ wo

    def _B_ref(x, w_r, w_gate, w_up, w_down):
        B, S, D = x.shape
        C = 8
        r = x @ w_r
        idx = torch.argsort(-r, axis=-1)[:, :C]
        idx_e = (lambda x, n, axis: torch.repeat_interleave(x, n, dim=axis))(idx.reshape(B, C, 1), D, axis=2)
        x_sel = (lambda x, i, axis: torch.take_along_dim(x, i, dim=axis))(x, idx_e, axis=1)
        g = _silu(x_sel @ w_gate)
        u = x_sel @ w_up
        y = (g * u) @ w_down
        r_sel = _sigmoid((lambda x, i, axis: torch.take_along_dim(x, i, dim=axis))(r, idx, axis=1))
        y = y * r_sel.reshape(B, C, 1)
        b_off = (torch.arange(B) * S).reshape(B, 1)
        flat_idx = (idx + b_off).reshape(B * C)
        zero = (x * 0.0).reshape(B * S, D)
        upd = _scatter_add(zero, flat_idx, y.reshape(B * C, D), axis=0)
        return x + upd.reshape(B, S, D)

    x = A_x
    g = _sigmoid((x * gate_w).sum(-1, keepdims=True))
    a = _A_ref(x, A_wqkv, A_wo)
    b = _B_ref(x, B_w_r, B_w_gate, B_w_up, B_w_down)
    return g * a + (1 - g) * b
```

```asm
; @launch grid=(256,1,1) block=(512,1,1) lds=163840
.amdgcn_target "amdgcn-amd-amdhsa--gfx950"
.text
.globl gated_mix__softmax_full_mha__moe_arch_mod__prompt_kernel
.p2align 8
.type gated_mix__softmax_full_mha__moe_arch_mod__prompt_kernel,@function
gated_mix__softmax_full_mha__moe_arch_mod__prompt_kernel:
    s_load_dwordx4 s[4:7], s[0:1], 0
    s_load_dwordx2 s[36:37], s[0:1], 88
    s_load_dwordx2 s[38:39], s[0:1], 16
    s_load_dwordx8 s[40:47], s[0:1], 32
    s_load_dwordx4 s[48:51], s[0:1], 64
    s_cmp_ge_u32 s2, 256
    s_cbranch_scc1 L_exit
    v_lshrrev_b32 v2, 6, v0
    v_and_b32 v3, 63, v0
    s_and_b32 s24, s2, 7
    s_lshr_b32 s25, s2, 3
    v_readfirstlane_b32 s33, v2
    s_and_b32 s31, s24, 1
    s_lshl_b32 s31, s31, 3
    s_and_b32 s26, s25, 7
    s_add_u32 s31, s31, s26
    s_lshr_b32 s27, s25, 3
    s_and_b32 s32, s24, 6
    s_lshl1_add_u32 s32, s32, s27
    s_add_u32 s3, s27, s26
    s_and_b32 s3, s3, 3
    s_lshl_b32 s3, s3, 1
    s_mov_b32 s28, 0x654e3210
    s_mov_b32 s29, 0xdcbaf987
    s_lshl_b32 s27, s31, 2
    s_lshr_b64 s[28:29], s[28:29], s27
    s_and_b32 s34, s28, 15
    v_lshlrev_b32 v1, 4, v3
    s_mov_b32 s27, 6856704
    s_cmp_lt_u32 s33, 4
    s_cbranch_scc1 L_main
    s_setprio 2
    s_sub_u32 s35, s33, 4
    v_lshrrev_b32 v4, 3, v3
    v_mul_u32_u24 v5, 896, v4
    v_and_b32 v6, 7, v3
    v_lshrrev_b32 v7, 4, v3
    v_xor_b32 v7, v6, v7
    v_lshl_add_u32 v10, v7, 4, v5
    v_xor_b32 v11, 64, v10
    v_add_u32 v12, 12288, v10
    v_add_u32 v13, 18432, v11
    v_add_u32 v11, 6144, v11
    v_mul_u32_u24 v5, 2688, v4
    v_and_b32 v4, 2, v4
    v_lshlrev_b32 v4, 1, v4
    v_xor_b32 v4, v4, v6
    v_lshl_add_u32 v14, v4, 4, v5
    v_add_u32 v15, 20480, v14
    s_lshl2_add_u32 s52, s32, s35
    s_mul_i32 s58, s52, 14
    s_add_u32 s58, s58, s34
    s_mul_i32 s58, s58, 5120
    v_and_b32 v8, 60, v3
    v_lshl_add_u32 v8, v8, 4, s58
    v_add_u32 v8, v8, v1
    s_mul_i32 s52, s52, 28672
    s_lshl_b32 s53, s34, 7
    s_mul_i32 s26, s35, 43008
    s_add_u32 s53, s53, s26
    s_add_u32 s53, s53, 896
    s_lshl_b32 s54, s35, 12
    s_lshl_b32 s55, s35, 11
    s_add_u32 s55, s55, 65536
    s_mov_b32 s56, s3
    s_mov_b32 s57, 0
    s_mov_b32 s14, 1835008
    s_mov_b32 s15, 0x20000
    s_cmp_ge_u32 s34, 14
    s_cselect_b32 s18, 0, 1204224
    s_mov_b32 s19, 0x20000
    s_waitcnt lgkmcnt(0)
    s_mov_b64 s[12:13], s[4:5]
    s_mov_b64 s[16:17], s[6:7]
    s_load_dword s30, s[36:37], s27
    s_cbranch_scc1 L_tbl
L_ld:
    s_mul_i32 s26, s56, 172032
    s_mov_b32 m0, s55
    s_add_u32 s26, s26, s53
    s_lshl_b32 s28, s56, 7
    buffer_load_dwordx4 v14, s[16:19], s26 offen lds
    buffer_load_dwordx4 v15, s[16:19], s26 offen offset:1024 lds
    s_mov_b32 m0, s54
    s_add_u32 s28, s28, s52
    buffer_load_dwordx4 v10, s[12:15], s28 offen lds
    buffer_load_dwordx4 v11, s[12:15], s28 offen offset:1024 lds
    buffer_load_dwordx4 v12, s[12:15], s28 offen offset:2048 lds
    buffer_load_dwordx4 v13, s[12:15], s28 offen offset:3072 lds
    s_add_u32 s55, s55, 8192
    s_add_u32 s54, s54, 16384
    s_and_b32 s54, s54, 0xffff
    s_add_u32 s56, s56, 1
    s_cmp_eq_u32 s56, 7
    s_cselect_b32 s56, 0, s56
    s_cmp_lg_u32 s57, 3
    s_cbranch_scc1 L_nt
    s_cmp_eq_u32 s18, 0
    s_cbranch_scc1 L_nt
    global_store_dwordx4 v8, v[10:13], s[36:37] sc1
    global_store_dwordx4 v8, v[10:13], s[36:37] offset:2048 sc1
L_nt:
    s_add_u32 s57, s57, 1
    s_cmp_lt_u32 s57, 3
    s_cbranch_scc1 L_ld
    s_waitcnt vmcnt(12)
    s_barrier
    s_cmp_lt_u32 s57, 7
    s_cbranch_scc1 L_ld
    v_lshrrev_b32 v4, 2, v3
    v_mul_u32_u24 v4, 2688, v4
    v_and_b32 v5, 3, v3
    v_lshl_add_u32 v16, v5, 4, v4
    s_mov_b32 s18, 1204224
    s_mul_i32 s53, s31, 56
    s_and_b32 s53, s53, 0xfffffff0
    s_mul_i32 s26, s35, 43008
    s_add_u32 s53, s53, s26
    s_lshl_b32 s55, s35, 10
    s_add_u32 s55, s55, 122880
    s_mul_i32 s26, s56, 172032
    s_add_u32 m0, s55, 0
    s_add_u32 s26, s26, s53
    buffer_load_dwordx4 v16, s[16:19], s26 offen lds
    s_add_u32 s56, s56, 1
    s_cmp_eq_u32 s56, 7
    s_cselect_b32 s56, 0, s56
    s_mul_i32 s26, s56, 172032
    s_add_u32 m0, s55, 4096
    s_add_u32 s26, s26, s53
    buffer_load_dwordx4 v16, s[16:19], s26 offen lds
    s_add_u32 s56, s56, 1
    s_cmp_eq_u32 s56, 7
    s_cselect_b32 s56, 0, s56
    s_waitcnt vmcnt(8)
    s_barrier
    s_mul_i32 s26, s56, 172032
    s_add_u32 m0, s55, 8192
    s_add_u32 s26, s26, s53
    buffer_load_dwordx4 v16, s[16:19], s26 offen lds
    s_add_u32 s56, s56, 1
    s_cmp_eq_u32 s56, 7
    s_cselect_b32 s56, 0, s56
    s_mul_i32 s26, s56, 172032
    s_add_u32 m0, s55, 12288
    s_add_u32 s26, s26, s53
    buffer_load_dwordx4 v16, s[16:19], s26 offen lds
    s_waitcnt vmcnt(4)
    s_barrier
    s_branch L_service
L_tbl:
    s_bitcmp1_b32 s35, 0
    s_cselect_b64 s[20:21], s[48:49], s[40:41]
    s_cselect_b32 s26, 1024, 0
    s_movk_i32 s22, 896
    s_mov_b32 s23, 0x20000
    s_add_u32 m0, s26, 160768
    s_lshl_b32 s28, s3, 7
    v_add_u32 v4, s28, v1
    v_subrev_u32 v6, 896, v4
    v_min_u32 v4, v4, v6
    buffer_load_dwordx4 v4, s[20:23], 0 offen lds
    s_branch L_ld
L_main:
    s_cmp_lg_u32 s33, 0
    s_cbranch_scc1 L_nopf
    s_getpc_b64 s[28:29]
L_pc:
    s_and_b32 s26, s25, 3
    s_lshl_b32 s26, s26, 13
    v_lshl_add_u32 v4, v3, 7, s26
    v_min_u32 v4, L_code_end-L_pc, v4
    global_load_dword v255, v4, s[28:29]
L_nopf:
    s_setprio 1
    v_and_b32 v226, 31, v3
    v_lshrrev_b32 v227, 5, v3
    v_mov_b32 v224, 1
    v_mov_b32 v225, 0
    v_mov_b32 v223, 163648
    v_lshrrev_b32 v4, 2, v1
    v_add_u32 v4, 163328, v4
    v_mov_b32 v6, -1
    s_mov_b32 exec_hi, 0
    ds_write_b32 v4, v6
    v_and_b32 v6, 7, v3
    v_cmp_eq_u32 vcc, 4, v6
    v_mov_b32 v7, 4587521
    s_nop 0
    v_cndmask_b32 v6, 0, v7, vcc
    ds_write_b32 v4, v6 offset:384
    s_mov_b32 exec_lo, 0xffff
    ds_write_b32 v4, v225 offset:320
    s_mov_b64 exec, -1
    v_lshrrev_b32 v4, 1, v226
    v_and_b32 v4, 7, v4
    v_xor_b32 v4, v4, v227
    v_lshlrev_b32 v4, 4, v4
    v_lshl_add_u32 v4, v226, 7, v4
    s_lshl_b32 s26, s33, 12
    v_add_u32 v216, s26, v4
    v_xor_b32 v217, 32, v216
    v_xor_b32 v218, 64, v216
    v_xor_b32 v219, 96, v216
    v_bfe_u32 v4, v3, 2, 2
    v_lshl_add_u32 v12, v227, 3, v4
    v_and_b32 v6, 3, v3
    v_and_b32 v7, 1, v3
    v_bfe_u32 v8, v3, 1, 1
    v_lshl_add_u32 v7, v7, 1, v8
    v_bfe_u32 v8, v3, 4, 1
    v_lshl_add_u32 v9, v8, 2, v7
    v_lshl_add_u32 v10, v8, 2, v6
    s_cmp_lt_u32 s34, 7
    s_cselect_b64 vcc, -1, 0
    v_cndmask_b32 v10, v10, v9, vcc
    v_lshlrev_b32 v11, 7, v12
    v_lshl_add_u32 v11, v10, 3, v11
    v_lshrrev_b32 v4, 1, v4
    v_lshl_add_u32 v11, v4, 6, v11
    v_add_u32 v220, 65536, v11
    v_xor_b32 v221, 64, v220
    v_add_u32 v10, 2, v9
    v_sub_u32 v11, 7, v9
    v_cmp_gt_u32 vcc, 6, v9
    s_nop 1
    v_cndmask_b32 v10, v11, v10, vcc
    s_bitcmp1_b32 s31, 0
    s_cselect_b64 vcc, -1, 0
    v_cndmask_b32 v10, v9, v10, vcc
    v_lshlrev_b32 v11, 6, v12
    v_lshl_add_u32 v11, v10, 3, v11
    v_add_u32 v222, 122880, v11
    v_lshrrev_b32 v4, 2, v3
    v_mul_u32_u24 v4, 2688, v4
    v_lshl_add_u32 v250, v6, 4, v4
    s_cmp_ge_u32 s34, 7
    s_cselect_b32 s26, 7, 0
    s_cselect_b32 s29, 2, 0
    s_sub_u32 s26, s34, s26
    s_mul_i32 s28, s26, 149824
    s_lshr_b32 s28, s28, 16
    v_add_u32 v4, s28, v6
    v_mul_u32_u24 v7, 28, v4
    v_lshrrev_b32 v7, 6, v7
    v_cmp_ge_u32 s[64:65], s26, v7
    v_cmp_ne_u32 vcc, s26, v7
    s_and_b32 s28, s32, 12
    s_add_u32 s29, s28, s29
    v_mov_b32 v7, s29
    v_addc_co_u32 v7, vcc, 0, v7, vcc
    s_and_b32 s28, s32, 3
    v_lshl_add_u32 v4, v4, 2, s28
    v_bfe_u32 v8, v3, 2, 2
    v_lshl_add_u32 v4, v4, 2, v8
    v_lshlrev_b32 v4, 7, v4
    v_lshl_add_u32 v252, v7, 2, v4
    s_and_b32 s64, s64, 0xffff
    s_cmp_ge_u32 s34, 14
    s_cselect_b32 s64, 0, s64
    s_mov_b32 s65, 0
    s_lshl_b32 s28, s33, 5
    v_add_u32 v251, s28, v223
    s_lshl_b32 s28, s32, 2
    s_lshr_b32 s58, s31, 2
    s_add_u32 s58, s58, s28
    s_and_b32 s59, s31, 3
    s_lshl2_add_u32 s59, s59, s33
    s_mul_i32 s59, s59, 56
    s_lshl_b32 s28, s58, 5
    v_add_u32 v4, s28, v226
    v_mul_u32_u24 v253, 896, v4
    v_lshl_add_u32 v253, v227, 4, v253
    v_lshlrev_b32 v254, 3, v4
    s_waitcnt lgkmcnt(0)
    s_mov_b32 s8, s36
    s_mov_b32 s9, s37
    s_mov_b32 s10, 0x10000000
    s_mov_b32 s11, 0x20000
    s_mov_b32 s16, s6
    s_mov_b32 s17, s7
    s_mov_b32 s18, 0x126000
    s_mov_b32 s19, 0x20000
    s_mov_b32 s12, s4
    s_mov_b32 s13, s5
    s_mov_b32 s14, 0x1c0000
    s_mov_b32 s15, 0x20000
    s_mul_i32 s62, s31, 56
    s_and_b32 s62, s62, 0xfffffff0
    s_mul_i32 s26, s33, 43008
    s_add_u32 s62, s62, s26
    s_lshl_b32 s63, s33, 10
    s_add_u32 s63, s63, 122880
    s_lshl2_add_u32 s35, s32, s33
    s_mul_i32 s52, s35, 14
    s_add_u32 s52, s52, s34
    s_mul_i32 s52, s52, 5120
    s_add_u32 s53, s52, 4096
    v_and_b32 v9, 19, v226
    v_bfe_u32 v4, v226, 2, 1
    v_lshl_add_u32 v9, v4, 3, v9
    v_bfe_u32 v4, v226, 3, 1
    v_lshl_add_u32 v9, v4, 2, v9
    s_lshr_b32 s26, s31, 1
    s_mul_i32 s26, s26, 7
    s_and_b32 s28, s31, 1
    s_lshl2_add_u32 s29, s28, s26
    v_add_u32 v4, s29, v227
    v_lshrrev_b32 v6, 3, v4
    v_mul_u32_u24 v6, 1024, v6
    v_lshl_add_u32 v6, v4, 9, v6
    v_lshl_add_u32 v228, v9, 4, v6
    v_add_u32 v4, 2, v4
    v_lshrrev_b32 v6, 3, v4
    v_mul_u32_u24 v6, 1024, v6
    v_lshl_add_u32 v6, v4, 9, v6
    s_add_u32 s26, s26, 3
    s_lshr_b32 s29, s26, 3
    s_mul_i32 s29, s29, 5120
    s_and_b32 s26, s26, 1
    s_lshl_b32 s26, s26, 9
    s_add_u32 s29, s29, s26
    s_add_u32 s29, s29, 4096
    v_mov_b32 v7, s29
    v_and_b32 v4, s28, v227
    v_cmp_eq_u32 vcc, 1, v4
    s_nop 1
    v_cndmask_b32 v6, v6, v7, vcc
    v_lshl_add_u32 v229, v9, 4, v6
    s_mul_i32 s26, s31, 28
    v_add_u32 v4, s26, v226
    v_lshrrev_b32 v6, 6, v4
    v_mul_u32_u24 v6, 5120, v6
    v_bfe_u32 v7, v4, 5, 1
    v_lshl_add_u32 v6, v7, 11, v6
    v_and_b32 v4, 31, v4
    v_lshl_add_u32 v6, v4, 4, v6
    v_lshl_add_u32 v6, v227, 9, v6
    v_add_u32 v6, 35840, v6
    v_add_u32 v8, 1024, v6
    s_lshr_b32 s26, s26, 6
    s_mul_i32 s26, s26, 5120
    s_add_u32 s26, s26, 39488
    v_lshl_add_u32 v7, v226, 4, s26
    v_cmp_le_u32 vcc, 28, v226
    s_nop 1
    v_cndmask_b32 v230, v6, v7, vcc
    v_cndmask_b32 v231, v8, v7, vcc
    s_cmp_ge_u32 s34, 14
    s_cbranch_scc1 L_roleR
    s_cmp_ge_u32 s34, 7
    s_cbranch_scc1 L_roleV
    v_add_u32 v4, s34, v227
    v_cmp_eq_u32 vcc, 3, v4
    v_cmp_eq_u32 s[20:21], 10, v4
    s_or_b64 s[20:21], s[20:21], vcc
    v_cmp_eq_u32 vcc, 1, v4
    v_cmp_eq_u32 s[22:23], 8, v4
    s_or_b64 s[22:23], s[22:23], vcc
    v_cmp_eq_u32 vcc, -1, v4
    v_cmp_eq_u32 s[24:25], 6, v4
    s_or_b64 s[24:25], s[24:25], vcc
    v_cmp_eq_u32 vcc, -3, v4
    v_cmp_eq_u32 s[26:27], 4, v4
    s_or_b64 s[26:27], s[26:27], vcc
    v_mov_b32 v232, 0x3f803f80
    v_mov_b32 v233, 0x3f803f80
    v_mov_b32 v234, 0x3f803f80
    v_mov_b32 v235, 0x3f803f80
    s_or_b64 s[28:29], s[20:21], s[22:23]
    s_or_b64 s[54:55], s[24:25], s[26:27]
    s_or_b64 s[54:55], s[54:55], s[28:29]
    s_mov_b64 exec, 0
    s_branch L_epi
L_backK:
    s_mov_b64 exec, -1
    s_barrier
    ds_read_b128 v[104:107], v216 offset:0
    ds_read_b64_tr_b16 v[72:73], v220 offset:0
    ds_read_b64_tr_b16 v[74:75], v220 offset:512
    ds_read_b64_tr_b16 v[76:77], v221 offset:0
    ds_read_b64_tr_b16 v[78:79], v221 offset:512
    ds_read_b128 v[108:111], v217 offset:0
    ds_read_b64_tr_b16 v[80:81], v220 offset:2048
    ds_read_b64_tr_b16 v[82:83], v220 offset:2560
    ds_read_b64_tr_b16 v[84:85], v221 offset:2048
    ds_read_b64_tr_b16 v[86:87], v221 offset:2560
    ds_read_b128 v[112:115], v218 offset:0
    ds_read_b64_tr_b16 v[88:89], v220 offset:4096
    ds_read_b64_tr_b16 v[90:91], v220 offset:4608
    ds_read_b64_tr_b16 v[92:93], v221 offset:4096
    ds_read_b64_tr_b16 v[94:95], v221 offset:4608
    s_waitcnt lgkmcnt(10)
    v_mfma_f32_32x32x16_bf16 v[40:55], v[72:75], v[104:107], 0
    v_mfma_f32_32x32x16_bf16 v[56:71], v[76:79], v[104:107], 0
    ds_read_b128 v[116:119], v219 offset:0
    ds_read_b64_tr_b16 v[96:97], v220 offset:6144
    ds_read_b64_tr_b16 v[98:99], v220 offset:6656
    ds_read_b64_tr_b16 v[100:101], v221 offset:6144
    ds_read_b64_tr_b16 v[102:103], v221 offset:6656
    s_waitcnt lgkmcnt(10)
    v_mfma_f32_32x32x16_bf16 v[40:55], v[80:83], v[108:111], v[40:55]
    v_mfma_f32_32x32x16_bf16 v[56:71], v[84:87], v[108:111], v[56:71]
    s_waitcnt lgkmcnt(5)
    v_mfma_f32_32x32x16_bf16 v[40:55], v[88:91], v[112:115], v[40:55]
    v_mfma_f32_32x32x16_bf16 v[56:71], v[92:95], v[112:115], v[56:71]
    s_waitcnt lgkmcnt(0)
    v_mfma_f32_32x32x16_bf16 v[40:55], v[96:99], v[116:119], v[40:55]
    v_mfma_f32_32x32x16_bf16 v[56:71], v[100:103], v[116:119], v[56:71]
    s_barrier
    ds_read_b128 v[120:123], v216 offset:16384
    ds_read_b64_tr_b16 v[72:73], v220 offset:8192
    ds_read_b64_tr_b16 v[74:75], v220 offset:8704
    ds_read_b64_tr_b16 v[76:77], v221 offset:8192
    ds_read_b64_tr_b16 v[78:79], v221 offset:8704
    ds_read_b128 v[124:127], v217 offset:16384
    ds_read_b64_tr_b16 v[80:81], v220 offset:10240
    ds_read_b64_tr_b16 v[82:83], v220 offset:10752
    ds_read_b64_tr_b16 v[84:85], v221 offset:10240
    ds_read_b64_tr_b16 v[86:87], v221 offset:10752
    ds_read_b128 v[128:131], v218 offset:16384
    ds_read_b64_tr_b16 v[88:89], v220 offset:12288
    ds_read_b64_tr_b16 v[90:91], v220 offset:12800
    ds_read_b64_tr_b16 v[92:93], v221 offset:12288
    ds_read_b64_tr_b16 v[94:95], v221 offset:12800
    s_waitcnt lgkmcnt(10)
    v_mfma_f32_32x32x16_bf16 v[40:55], v[72:75], v[120:123], v[40:55]
    v_mfma_f32_32x32x16_bf16 v[56:71], v[76:79], v[120:123], v[56:71]
    ds_read_b128 v[132:135], v219 offset:16384
    ds_read_b64_tr_b16 v[96:97], v220 offset:14336
    ds_read_b64_tr_b16 v[98:99], v220 offset:14848
    ds_read_b64_tr_b16 v[100:101], v221 offset:14336
    ds_read_b64_tr_b16 v[102:103], v221 offset:14848
    s_waitcnt lgkmcnt(10)
    v_mfma_f32_32x32x16_bf16 v[40:55], v[80:83], v[124:127], v[40:55]
    v_mfma_f32_32x32x16_bf16 v[56:71], v[84:87], v[124:127], v[56:71]
    s_waitcnt lgkmcnt(5)
    v_mfma_f32_32x32x16_bf16 v[40:55], v[88:91], v[128:131], v[40:55]
    v_mfma_f32_32x32x16_bf16 v[56:71], v[92:95], v[128:131], v[56:71]
    s_waitcnt lgkmcnt(0)
    v_mfma_f32_32x32x16_bf16 v[40:55], v[96:99], v[132:135], v[40:55]
    v_mfma_f32_32x32x16_bf16 v[56:71], v[100:103], v[132:135], v[56:71]
    s_barrier
    ds_read_b128 v[136:139], v216 offset:32768
    ds_read_b64_tr_b16 v[72:73], v220 offset:16384
    ds_read_b64_tr_b16 v[74:75], v220 offset:16896
    ds_read_b64_tr_b16 v[76:77], v221 offset:16384
    ds_read_b64_tr_b16 v[78:79], v221 offset:16896
    ds_read_b128 v[140:143], v217 offset:32768
    ds_read_b64_tr_b16 v[80:81], v220 offset:18432
    ds_read_b64_tr_b16 v[82:83], v220 offset:18944
    ds_read_b64_tr_b16 v[84:85], v221 offset:18432
    ds_read_b64_tr_b16 v[86:87], v221 offset:18944
    ds_read_b128 v[144:147], v218 offset:32768
    ds_read_b64_tr_b16 v[88:89], v220 offset:20480
    ds_read_b64_tr_b16 v[90:91], v220 offset:20992
    ds_read_b64_tr_b16 v[92:93], v221 offset:20480
    ds_read_b64_tr_b16 v[94:95], v221 offset:20992
    s_waitcnt lgkmcnt(10)
    v_mfma_f32_32x32x16_bf16 v[40:55], v[72:75], v[136:139], v[40:55]
    v_mfma_f32_32x32x16_bf16 v[56:71], v[76:79], v[136:139], v[56:71]
    ds_read_b128 v[148:151], v219 offset:32768
    ds_read_b64_tr_b16 v[96:97], v220 offset:22528
    ds_read_b64_tr_b16 v[98:99], v220 offset:23040
    ds_read_b64_tr_b16 v[100:101], v221 offset:22528
    ds_read_b64_tr_b16 v[102:103], v221 offset:23040
    s_waitcnt lgkmcnt(10)
    v_mfma_f32_32x32x16_bf16 v[40:55], v[80:83], v[140:143], v[40:55]
    v_mfma_f32_32x32x16_bf16 v[56:71], v[84:87], v[140:143], v[56:71]
    s_waitcnt lgkmcnt(5)
    v_mfma_f32_32x32x16_bf16 v[40:55], v[88:91], v[144:147], v[40:55]
    v_mfma_f32_32x32x16_bf16 v[56:71], v[92:95], v[144:147], v[56:71]
    s_waitcnt lgkmcnt(0)
    v_mfma_f32_32x32x16_bf16 v[40:55], v[96:99], v[148:151], v[40:55]
    v_mfma_f32_32x32x16_bf16 v[56:71], v[100:103], v[148:151], v[56:71]
    s_barrier
    ds_read_b128 v[152:155], v216 offset:49152
    ds_read_b64_tr_b16 v[72:73], v220 offset:24576
    ds_read_b64_tr_b16 v[74:75], v220 offset:25088
    ds_read_b64_tr_b16 v[76:77], v221 offset:24576
    ds_read_b64_tr_b16 v[78:79], v221 offset:25088
    ds_read_b128 v[156:159], v217 offset:49152
    ds_read_b64_tr_b16 v[80:81], v220 offset:26624
    ds_read_b64_tr_b16 v[82:83], v220 offset:27136
    ds_read_b64_tr_b16 v[84:85], v221 offset:26624
    ds_read_b64_tr_b16 v[86:87], v221 offset:27136
    ds_read_b128 v[160:163], v218 offset:49152
    ds_read_b64_tr_b16 v[88:89], v220 offset:28672
    ds_read_b64_tr_b16 v[90:91], v220 offset:29184
    ds_read_b64_tr_b16 v[92:93], v221 offset:28672
    ds_read_b64_tr_b16 v[94:95], v221 offset:29184
    s_waitcnt lgkmcnt(10)
    v_mfma_f32_32x32x16_bf16 v[40:55], v[72:75], v[152:155], v[40:55]
    v_mfma_f32_32x32x16_bf16 v[56:71], v[76:79], v[152:155], v[56:71]
    ds_read_b128 v[164:167], v219 offset:49152
    ds_read_b64_tr_b16 v[96:97], v220 offset:30720
    ds_read_b64_tr_b16 v[98:99], v220 offset:31232
    ds_read_b64_tr_b16 v[100:101], v221 offset:30720
    ds_read_b64_tr_b16 v[102:103], v221 offset:31232
    s_waitcnt lgkmcnt(10)
    v_mfma_f32_32x32x16_bf16 v[40:55], v[80:83], v[156:159], v[40:55]
    v_mfma_f32_32x32x16_bf16 v[56:71], v[84:87], v[156:159], v[56:71]
    s_waitcnt lgkmcnt(5)
    v_mfma_f32_32x32x16_bf16 v[40:55], v[88:91], v[160:163], v[40:55]
    v_mfma_f32_32x32x16_bf16 v[56:71], v[92:95], v[160:163], v[56:71]
    s_waitcnt lgkmcnt(0)
    v_mfma_f32_32x32x16_bf16 v[40:55], v[96:99], v[164:167], v[40:55]
    v_mfma_f32_32x32x16_bf16 v[56:71], v[100:103], v[164:167], v[56:71]
    s_barrier
    ds_read_b128 v[168:171], v216 offset:0
    ds_read_b64_tr_b16 v[72:73], v220 offset:32768
    ds_read_b64_tr_b16 v[74:75], v220 offset:33280
    ds_read_b64_tr_b16 v[76:77], v221 offset:32768
    ds_read_b64_tr_b16 v[78:79], v221 offset:33280
    ds_read_b128 v[172:175], v217 offset:0
    ds_read_b64_tr_b16 v[80:81], v220 offset:34816
    ds_read_b64_tr_b16 v[82:83], v220 offset:35328
    ds_read_b64_tr_b16 v[84:85], v221 offset:34816
    ds_read_b64_tr_b16 v[86:87], v221 offset:35328
    ds_read_b128 v[176:179], v218 offset:0
    ds_read_b64_tr_b16 v[88:89], v220 offset:36864
    ds_read_b64_tr_b16 v[90:91], v220 offset:37376
    ds_read_b64_tr_b16 v[92:93], v221 offset:36864
    ds_read_b64_tr_b16 v[94:95], v221 offset:37376
    s_waitcnt lgkmcnt(10)
    v_mfma_f32_32x32x16_bf16 v[40:55], v[72:75], v[168:171], v[40:55]
    v_mfma_f32_32x32x16_bf16 v[56:71], v[76:79], v[168:171], v[56:71]
    ds_read_b128 v[180:183], v219 offset:0
    ds_read_b64_tr_b16 v[96:97], v220 offset:38912
    ds_read_b64_tr_b16 v[98:99], v220 offset:39424
    ds_read_b64_tr_b16 v[100:101], v221 offset:38912
    ds_read_b64_tr_b16 v[102:103], v221 offset:39424
    s_waitcnt lgkmcnt(10)
    v_mfma_f32_32x32x16_bf16 v[40:55], v[80:83], v[172:175], v[40:55]
    v_mfma_f32_32x32x16_bf16 v[56:71], v[84:87], v[172:175], v[56:71]
    s_waitcnt lgkmcnt(5)
    v_mfma_f32_32x32x16_bf16 v[40:55], v[88:91], v[176:179], v[40:55]
    v_mfma_f32_32x32x16_bf16 v[56:71], v[92:95], v[176:179], v[56:71]
    s_waitcnt lgkmcnt(0)
    v_mfma_f32_32x32x16_bf16 v[40:55], v[96:99], v[180:183], v[40:55]
    v_mfma_f32_32x32x16_bf16 v[56:71], v[100:103], v[180:183], v[56:71]
    s_barrier
    ds_read_b128 v[184:187], v216 offset:16384
    ds_read_b64_tr_b16 v[72:73], v220 offset:40960
    ds_read_b64_tr_b16 v[74:75], v220 offset:41472
    ds_read_b64_tr_b16 v[76:77], v221 offset:40960
    ds_read_b64_tr_b16 v[78:79], v221 offset:41472
    ds_read_b128 v[188:191], v217 offset:16384
    ds_read_b64_tr_b16 v[80:81], v220 offset:43008
    ds_read_b64_tr_b16 v[82:83], v220 offset:43520
    ds_read_b64_tr_b16 v[84:85], v221 offset:43008
    ds_read_b64_tr_b16 v[86:87], v221 offset:43520
    ds_read_b128 v[192:195], v218 offset:16384
    ds_read_b64_tr_b16 v[88:89], v220 offset:45056
    ds_read_b64_tr_b16 v[90:91], v220 offset:45568
    ds_read_b64_tr_b16 v[92:93], v221 offset:45056
    ds_read_b64_tr_b16 v[94:95], v221 offset:45568
    s_waitcnt lgkmcnt(10)
    v_mfma_f32_32x32x16_bf16 v[40:55], v[72:75], v[184:187], v[40:55]
    v_mfma_f32_32x32x16_bf16 v[56:71], v[76:79], v[184:187], v[56:71]
    ds_read_b128 v[196:199], v219 offset:16384
    ds_read_b64_tr_b16 v[96:97], v220 offset:47104
    ds_read_b64_tr_b16 v[98:99], v220 offset:47616
    ds_read_b64_tr_b16 v[100:101], v221 offset:47104
    ds_read_b64_tr_b16 v[102:103], v221 offset:47616
    s_waitcnt lgkmcnt(10)
    v_mfma_f32_32x32x16_bf16 v[40:55], v[80:83], v[188:191], v[40:55]
    v_mfma_f32_32x32x16_bf16 v[56:71], v[84:87], v[188:191], v[56:71]
    s_waitcnt lgkmcnt(5)
    v_mfma_f32_32x32x16_bf16 v[40:55], v[88:91], v[192:195], v[40:55]
    v_mfma_f32_32x32x16_bf16 v[56:71], v[92:95], v[192:195], v[56:71]
    s_waitcnt lgkmcnt(0)
    v_mfma_f32_32x32x16_bf16 v[40:55], v[96:99], v[196:199], v[40:55]
    v_mfma_f32_32x32x16_bf16 v[56:71], v[100:103], v[196:199], v[56:71]
    s_barrier
    ds_read_b128 v[200:203], v216 offset:32768
    ds_read_b64_tr_b16 v[72:73], v220 offset:49152
    ds_read_b64_tr_b16 v[74:75], v220 offset:49664
    ds_read_b64_tr_b16 v[76:77], v221 offset:49152
    ds_read_b64_tr_b16 v[78:79], v221 offset:49664
    ds_read_b128 v[204:207], v217 offset:32768
    ds_read_b64_tr_b16 v[80:81], v220 offset:51200
    ds_read_b64_tr_b16 v[82:83], v220 offset:51712
    ds_read_b64_tr_b16 v[84:85], v221 offset:51200
    ds_read_b64_tr_b16 v[86:87], v221 offset:51712
    ds_read_b128 v[208:211], v218 offset:32768
    ds_read_b64_tr_b16 v[88:89], v220 offset:53248
    ds_read_b64_tr_b16 v[90:91], v220 offset:53760
    ds_read_b64_tr_b16 v[92:93], v221 offset:53248
    ds_read_b64_tr_b16 v[94:95], v221 offset:53760
    s_waitcnt lgkmcnt(10)
    v_mfma_f32_32x32x16_bf16 v[40:55], v[72:75], v[200:203], v[40:55]
    v_mfma_f32_32x32x16_bf16 v[56:71], v[76:79], v[200:203], v[56:71]
    ds_read_b128 v[212:215], v219 offset:32768
    ds_read_b64_tr_b16 v[96:97], v220 offset:55296
    ds_read_b64_tr_b16 v[98:99], v220 offset:55808
    ds_read_b64_tr_b16 v[100:101], v221 offset:55296
    ds_read_b64_tr_b16 v[102:103], v221 offset:55808
    s_waitcnt lgkmcnt(10)
    v_mfma_f32_32x32x16_bf16 v[40:55], v[80:83], v[204:207], v[40:55]
    v_mfma_f32_32x32x16_bf16 v[56:71], v[84:87], v[204:207], v[56:71]
    s_waitcnt lgkmcnt(5)
    v_mfma_f32_32x32x16_bf16 v[40:55], v[88:91], v[208:211], v[40:55]
    s_waitcnt lgkmcnt(0)
    v_mfma_f32_32x32x16_bf16 v[40:55], v[96:99], v[212:215], v[40:55]
    v_mfma_f32_32x32x16_bf16 v[56:71], v[92:95], v[208:211], v[56:71]
    v_mfma_f32_32x32x16_bf16 v[56:71], v[100:103], v[212:215], v[56:71]
    s_branch L_epi
L_roleR:
    v_and_b32 v4, 1, v3
    v_lshlrev_b32 v4, 10, v4
    v_lshl_add_u32 v4, v227, 4, v4
    v_add_u32 v220, 160768, v4
    s_lshl_b32 s26, s33, 7
    s_add_u32 s26, s26, 159744
    v_lshl_add_u32 v12, v226, 2, s26
    v_lshl_add_u32 v13, v227, 6, s26
    s_barrier
    ds_read_b128 v[104:107], v216 offset:0
    ds_read_b128 v[72:75], v220 offset:0
    ds_read_b128 v[108:111], v217 offset:0
    ds_read_b128 v[80:83], v220 offset:32
    ds_read_b128 v[112:115], v218 offset:0
    ds_read_b128 v[88:91], v220 offset:64
    s_waitcnt lgkmcnt(4)
    v_mfma_f32_32x32x16_bf16 v[40:55], v[72:75], v[104:107], 0
    ds_read_b128 v[116:119], v219 offset:0
    ds_read_b128 v[96:99], v220 offset:96
    s_waitcnt lgkmcnt(4)
    v_mfma_f32_32x32x16_bf16 v[40:55], v[80:83], v[108:111], v[40:55]
    s_waitcnt lgkmcnt(2)
    v_mfma_f32_32x32x16_bf16 v[40:55], v[88:91], v[112:115], v[40:55]
    s_waitcnt lgkmcnt(0)
    v_mfma_f32_32x32x16_bf16 v[40:55], v[96:99], v[116:119], v[40:55]
    s_barrier
    ds_read_b128 v[120:123], v216 offset:16384
    ds_read_b128 v[72:75], v220 offset:128
    ds_read_b128 v[124:127], v217 offset:16384
    ds_read_b128 v[80:83], v220 offset:160
    ds_read_b128 v[128:131], v218 offset:16384
    ds_read_b128 v[88:91], v220 offset:192
    s_waitcnt lgkmcnt(4)
    v_mfma_f32_32x32x16_bf16 v[40:55], v[72:75], v[120:123], v[40:55]
    ds_read_b128 v[132:135], v219 offset:16384
    ds_read_b128 v[96:99], v220 offset:224
    s_waitcnt lgkmcnt(4)
    v_mfma_f32_32x32x16_bf16 v[40:55], v[80:83], v[124:127], v[40:55]
    s_waitcnt lgkmcnt(2)
    v_mfma_f32_32x32x16_bf16 v[40:55], v[88:91], v[128:131], v[40:55]
    s_waitcnt lgkmcnt(0)
    v_mfma_f32_32x32x16_bf16 v[40:55], v[96:99], v[132:135], v[40:55]
    s_barrier
    ds_read_b128 v[136:139], v216 offset:32768
    ds_read_b128 v[72:75], v220 offset:256
    ds_read_b128 v[140:143], v217 offset:32768
    ds_read_b128 v[80:83], v220 offset:288
    ds_read_b128 v[144:147], v218 offset:32768
    ds_read_b128 v[88:91], v220 offset:320
    s_waitcnt lgkmcnt(4)
    v_mfma_f32_32x32x16_bf16 v[40:55], v[72:75], v[136:139], v[40:55]
    ds_read_b128 v[148:151], v219 offset:32768
    ds_read_b128 v[96:99], v220 offset:352
    s_waitcnt lgkmcnt(4)
    v_mfma_f32_32x32x16_bf16 v[40:55], v[80:83], v[140:143], v[40:55]
    s_waitcnt lgkmcnt(2)
    v_mfma_f32_32x32x16_bf16 v[40:55], v[88:91], v[144:147], v[40:55]
    s_waitcnt lgkmcnt(0)
    v_mfma_f32_32x32x16_bf16 v[40:55], v[96:99], v[148:151], v[40:55]
    s_barrier
    ds_read_b128 v[152:155], v216 offset:49152
    ds_read_b128 v[72:75], v220 offset:384
    ds_read_b128 v[156:159], v217 offset:49152
    ds_read_b128 v[80:83], v220 offset:416
    ds_read_b128 v[160:163], v218 offset:49152
    ds_read_b128 v[88:91], v220 offset:448
    s_waitcnt lgkmcnt(4)
    v_mfma_f32_32x32x16_bf16 v[40:55], v[72:75], v[152:155], v[40:55]
    ds_read_b128 v[164:167], v219 offset:49152
    ds_read_b128 v[96:99], v220 offset:480
    s_waitcnt lgkmcnt(4)
    v_mfma_f32_32x32x16_bf16 v[40:55], v[80:83], v[156:159], v[40:55]
    s_waitcnt lgkmcnt(2)
    v_mfma_f32_32x32x16_bf16 v[40:55], v[88:91], v[160:163], v[40:55]
    s_waitcnt lgkmcnt(0)
    v_mfma_f32_32x32x16_bf16 v[40:55], v[96:99], v[164:167], v[40:55]
    s_barrier
    ds_read_b128 v[168:171], v216 offset:0
    ds_read_b128 v[72:75], v220 offset:512
    ds_read_b128 v[172:175], v217 offset:0
    ds_read_b128 v[80:83], v220 offset:544
    ds_read_b128 v[176:179], v218 offset:0
    ds_read_b128 v[88:91], v220 offset:576
    s_waitcnt lgkmcnt(4)
    v_mfma_f32_32x32x16_bf16 v[40:55], v[72:75], v[168:171], v[40:55]
    ds_read_b128 v[180:183], v219 offset:0
    ds_read_b128 v[96:99], v220 offset:608
    s_waitcnt lgkmcnt(4)
    v_mfma_f32_32x32x16_bf16 v[40:55], v[80:83], v[172:175], v[40:55]
    s_waitcnt lgkmcnt(2)
    v_mfma_f32_32x32x16_bf16 v[40:55], v[88:91], v[176:179], v[40:55]
    s_waitcnt lgkmcnt(0)
    v_mfma_f32_32x32x16_bf16 v[40:55], v[96:99], v[180:183], v[40:55]
    s_barrier
    ds_read_b128 v[184:187], v216 offset:16384
    ds_read_b128 v[72:75], v220 offset:640
    ds_read_b128 v[188:191], v217 offset:16384
    ds_read_b128 v[80:83], v220 offset:672
    ds_read_b128 v[192:195], v218 offset:16384
    ds_read_b128 v[88:91], v220 offset:704
    s_waitcnt lgkmcnt(4)
    v_mfma_f32_32x32x16_bf16 v[40:55], v[72:75], v[184:187], v[40:55]
    ds_read_b128 v[196:199], v219 offset:16384
    ds_read_b128 v[96:99], v220 offset:736
    s_waitcnt lgkmcnt(4)
    v_mfma_f32_32x32x16_bf16 v[40:55], v[80:83], v[188:191], v[40:55]
    s_waitcnt lgkmcnt(2)
    v_mfma_f32_32x32x16_bf16 v[40:55], v[88:91], v[192:195], v[40:55]
    s_waitcnt lgkmcnt(0)
    v_mfma_f32_32x32x16_bf16 v[40:55], v[96:99], v[196:199], v[40:55]
    s_barrier
    ds_read_b128 v[200:203], v216 offset:32768
    ds_read_b128 v[72:75], v220 offset:768
    ds_read_b128 v[204:207], v217 offset:32768
    ds_read_b128 v[80:83], v220 offset:800
    ds_read_b128 v[208:211], v218 offset:32768
    ds_read_b128 v[88:91], v220 offset:832
    s_waitcnt lgkmcnt(4)
    v_mfma_f32_32x32x16_bf16 v[40:55], v[72:75], v[200:203], v[40:55]
    ds_read_b128 v[212:215], v219 offset:32768
    ds_read_b128 v[96:99], v220 offset:864
    s_waitcnt lgkmcnt(4)
    v_mfma_f32_32x32x16_bf16 v[40:55], v[80:83], v[204:207], v[40:55]
    s_waitcnt lgkmcnt(2)
    v_mfma_f32_32x32x16_bf16 v[40:55], v[88:91], v[208:211], v[40:55]
    s_waitcnt lgkmcnt(0)
    v_mfma_f32_32x32x16_bf16 v[40:55], v[96:99], v[212:215], v[40:55]
    s_cmp_lg_u32 s34, 14
    s_cbranch_scc1 L_pub
    s_mov_b32 exec_hi, 0
    s_nop 9
    v_cvt_pk_bf16_f32 v4, v40, v41
    v_and_b32 v5, 0xffff0000, v4
    v_lshlrev_b32 v4, 16, v4
    v_ashrrev_i32 v6, 31, v4
    v_or_b32 v6, 0x80000000, v6
    v_xor_b32 v6, v6, v4
    v_lshrrev_b32 v6, 16, v6
    v_lshlrev_b32 v6, 11, v6
    v_cmp_u_f32 vcc, v4, v4
    s_nop 1
    v_cndmask_b32 v6, v6, 0, vcc
    s_lshl_b32 s26, s35, 5
    v_add_u32 v7, s26, v226
    v_sub_u32 v8, 0x7ff, v7
    v_or_b32 v6, v6, v8
    v_lshlrev_b32 v9, 3, v7
    ds_write_b32 v12, v6
    s_mov_b32 exec_hi, -1
    ds_read_b32 v6, v12
    ds_read_b128 v[16:19], v13
    ds_read_b128 v[20:23], v13 offset:16
    ds_read_b128 v[24:27], v13 offset:32
    ds_read_b128 v[28:31], v13 offset:48
    v_mov_b32 v14, 0
    v_mov_b32 v15, 0
    s_waitcnt lgkmcnt(3)
    v_sub_u32 v16, v6, v16
    v_sub_u32 v17, v6, v17
    v_sub_u32 v18, v6, v18
    v_sub_u32 v19, v6, v19
    v_alignbit_b32 v14, v14, v16, 31
    v_alignbit_b32 v15, v15, v17, 31
    v_alignbit_b32 v14, v14, v18, 31
    v_alignbit_b32 v15, v15, v19, 31
    s_waitcnt lgkmcnt(2)
    v_sub_u32 v20, v6, v20
    v_sub_u32 v21, v6, v21
    v_sub_u32 v22, v6, v22
    v_sub_u32 v23, v6, v23
    v_alignbit_b32 v14, v14, v20, 31
    v_alignbit_b32 v15, v15, v21, 31
    v_alignbit_b32 v14, v14, v22, 31
    v_alignbit_b32 v15, v15, v23, 31
    s_waitcnt lgkmcnt(1)
    v_sub_u32 v24, v6, v24
    v_sub_u32 v25, v6, v25
    v_sub_u32 v26, v6, v26
    v_sub_u32 v27, v6, v27
    v_alignbit_b32 v14, v14, v24, 31
    v_alignbit_b32 v15, v15, v25, 31
    v_alignbit_b32 v14, v14, v26, 31
    v_alignbit_b32 v15, v15, v27, 31
    s_waitcnt lgkmcnt(0)
    v_sub_u32 v28, v6, v28
    v_sub_u32 v29, v6, v29
    v_sub_u32 v30, v6, v30
    v_sub_u32 v31, v6, v31
    v_alignbit_b32 v14, v14, v28, 31
    v_alignbit_b32 v15, v15, v29, 31
    v_alignbit_b32 v14, v14, v30, 31
    v_alignbit_b32 v15, v15, v31, 31
    v_bcnt_u32_b32 v14, v14, 0
    v_bcnt_u32_b32 v14, v15, v14
    v_mov_b32 v15, v14
    s_lshl_b32 s26, s33, 5
    s_add_u32 s26, s26, 160256
    v_permlane32_swap_b32 v14, v15
    v_add_u32 v14, v14, v15
    v_cmp_gt_u32 vcc, 8, v14
    v_lshl_add_u32 v14, v14, 2, s26
    s_mov_b64 exec, vcc
    ds_write_b32 v14, v6
    s_mov_b64 exec, 1
    ds_add_u32 v223, v224 offset:40
    s_mov_b32 exec_lo, -1
    v_mul_f32 v5, 0xbfb8aa3b, v5
    v_exp_f32 v5, v5
    s_nop 0
    v_add_f32 v5, 1.0, v5
    v_rcp_f32 v5, v5
    s_nop 0
    v_cvt_pk_bf16_f32 v5, v5, v5
    v_lshlrev_b32 v10, 16, v5
    s_mov_b32 exec_hi, -1
    s_branch L_pub
L_roleV:
    v_cmp_eq_u32 vcc, 0, v3
    v_mov_b32 v7, 0x3f803f80
    s_nop 0
    v_cndmask_b32 v232, 0, v7, vcc
    v_mov_b32 v233, v232
    v_mov_b32 v234, v232
    v_mov_b32 v235, v232
    s_mov_b64 s[20:21], 0
    s_mov_b64 s[22:23], 0
    s_mov_b64 s[24:25], 0
    s_mov_b64 s[26:27], 0
    s_mov_b64 s[54:55], 0xff
    s_barrier
    ds_read_b128 v[104:107], v216 offset:0
    ds_read_b64_tr_b16 v[72:73], v220 offset:0
    ds_read_b64_tr_b16 v[74:75], v220 offset:512
    ds_read_b64_tr_b16 v[76:77], v221 offset:0
    ds_read_b64_tr_b16 v[78:79], v221 offset:512
    ds_read_b128 v[108:111], v217 offset:0
    ds_read_b64_tr_b16 v[80:81], v220 offset:2048
    ds_read_b64_tr_b16 v[82:83], v220 offset:2560
    ds_read_b64_tr_b16 v[84:85], v221 offset:2048
    ds_read_b64_tr_b16 v[86:87], v221 offset:2560
    ds_read_b128 v[112:115], v218 offset:0
    ds_read_b64_tr_b16 v[88:89], v220 offset:4096
    ds_read_b64_tr_b16 v[90:91], v220 offset:4608
    ds_read_b64_tr_b16 v[92:93], v221 offset:4096
    ds_read_b64_tr_b16 v[94:95], v221 offset:4608
    s_waitcnt lgkmcnt(10)
    v_mfma_f32_32x32x16_bf16 v[40:55], v[104:107], v[72:75], 0
    v_mfma_f32_32x32x16_bf16 v[56:71], v[104:107], v[76:79], 0
    ds_read_b128 v[116:119], v219 offset:0
    ds_read_b64_tr_b16 v[96:97], v220 offset:6144
    ds_read_b64_tr_b16 v[98:99], v220 offset:6656
    ds_read_b64_tr_b16 v[100:101], v221 offset:6144
    ds_read_b64_tr_b16 v[102:103], v221 offset:6656
    s_waitcnt lgkmcnt(10)
    v_mfma_f32_32x32x16_bf16 v[40:55], v[108:111], v[80:83], v[40:55]
    v_mfma_f32_32x32x16_bf16 v[56:71], v[108:111], v[84:87], v[56:71]
    s_waitcnt lgkmcnt(5)
    v_mfma_f32_32x32x16_bf16 v[40:55], v[112:115], v[88:91], v[40:55]
    v_mfma_f32_32x32x16_bf16 v[56:71], v[112:115], v[92:95], v[56:71]
    s_waitcnt lgkmcnt(0)
    v_mfma_f32_32x32x16_bf16 v[40:55], v[116:119], v[96:99], v[40:55]
    v_mfma_f32_32x32x16_bf16 v[56:71], v[116:119], v[100:103], v[56:71]
    s_barrier
    ds_read_b128 v[120:123], v216 offset:16384
    ds_read_b64_tr_b16 v[72:73], v220 offset:8192
    ds_read_b64_tr_b16 v[74:75], v220 offset:8704
    ds_read_b64_tr_b16 v[76:77], v221 offset:8192
    ds_read_b64_tr_b16 v[78:79], v221 offset:8704
    ds_read_b128 v[124:127], v217 offset:16384
    ds_read_b64_tr_b16 v[80:81], v220 offset:10240
    ds_read_b64_tr_b16 v[82:83], v220 offset:10752
    ds_read_b64_tr_b16 v[84:85], v221 offset:10240
    ds_read_b64_tr_b16 v[86:87], v221 offset:10752
    ds_read_b128 v[128:131], v218 offset:16384
    ds_read_b64_tr_b16 v[88:89], v220 offset:12288
    ds_read_b64_tr_b16 v[90:91], v220 offset:12800
    ds_read_b64_tr_b16 v[92:93], v221 offset:12288
    ds_read_b64_tr_b16 v[94:95], v221 offset:12800
    s_waitcnt lgkmcnt(10)
    v_mfma_f32_32x32x16_bf16 v[40:55], v[120:123], v[72:75], v[40:55]
    v_mfma_f32_32x32x16_bf16 v[56:71], v[120:123], v[76:79], v[56:71]
    ds_read_b128 v[132:135], v219 offset:16384
    ds_read_b64_tr_b16 v[96:97], v220 offset:14336
    ds_read_b64_tr_b16 v[98:99], v220 offset:14848
    ds_read_b64_tr_b16 v[100:101], v221 offset:14336
    ds_read_b64_tr_b16 v[102:103], v221 offset:14848
    s_waitcnt lgkmcnt(10)
    v_mfma_f32_32x32x16_bf16 v[40:55], v[124:127], v[80:83], v[40:55]
    v_mfma_f32_32x32x16_bf16 v[56:71], v[124:127], v[84:87], v[56:71]
    s_waitcnt lgkmcnt(5)
    v_mfma_f32_32x32x16_bf16 v[40:55], v[128:131], v[88:91], v[40:55]
    v_mfma_f32_32x32x16_bf16 v[56:71], v[128:131], v[92:95], v[56:71]
    s_waitcnt lgkmcnt(0)
    v_mfma_f32_32x32x16_bf16 v[40:55], v[132:135], v[96:99], v[40:55]
    v_mfma_f32_32x32x16_bf16 v[56:71], v[132:135], v[100:103], v[56:71]
    s_barrier
    ds_read_b128 v[136:139], v216 offset:32768
    ds_read_b64_tr_b16 v[72:73], v220 offset:16384
    ds_read_b64_tr_b16 v[74:75], v220 offset:16896
    ds_read_b64_tr_b16 v[76:77], v221 offset:16384
    ds_read_b64_tr_b16 v[78:79], v221 offset:16896
    ds_read_b128 v[140:143], v217 offset:32768
    ds_read_b64_tr_b16 v[80:81], v220 offset:18432
    ds_read_b64_tr_b16 v[82:83], v220 offset:18944
    ds_read_b64_tr_b16 v[84:85], v221 offset:18432
    ds_read_b64_tr_b16 v[86:87], v221 offset:18944
    ds_read_b128 v[144:147], v218 offset:32768
    ds_read_b64_tr_b16 v[88:89], v220 offset:20480
    ds_read_b64_tr_b16 v[90:91], v220 offset:20992
    ds_read_b64_tr_b16 v[92:93], v221 offset:20480
    ds_read_b64_tr_b16 v[94:95], v221 offset:20992
    s_waitcnt lgkmcnt(10)
    v_mfma_f32_32x32x16_bf16 v[40:55], v[136:139], v[72:75], v[40:55]
    v_mfma_f32_32x32x16_bf16 v[56:71], v[136:139], v[76:79], v[56:71]
    ds_read_b128 v[148:151], v219 offset:32768
    ds_read_b64_tr_b16 v[96:97], v220 offset:22528
    ds_read_b64_tr_b16 v[98:99], v220 offset:23040
    ds_read_b64_tr_b16 v[100:101], v221 offset:22528
    ds_read_b64_tr_b16 v[102:103], v221 offset:23040
    s_waitcnt lgkmcnt(10)
    v_mfma_f32_32x32x16_bf16 v[40:55], v[140:143], v[80:83], v[40:55]
    v_mfma_f32_32x32x16_bf16 v[56:71], v[140:143], v[84:87], v[56:71]
    s_waitcnt lgkmcnt(5)
    v_mfma_f32_32x32x16_bf16 v[40:55], v[144:147], v[88:91], v[40:55]
    v_mfma_f32_32x32x16_bf16 v[56:71], v[144:147], v[92:95], v[56:71]
    s_waitcnt lgkmcnt(0)
    v_mfma_f32_32x32x16_bf16 v[40:55], v[148:151], v[96:99], v[40:55]
    v_mfma_f32_32x32x16_bf16 v[56:71], v[148:151], v[100:103], v[56:71]
    s_barrier
    ds_read_b128 v[152:155], v216 offset:49152
    ds_read_b64_tr_b16 v[72:73], v220 offset:24576
    ds_read_b64_tr_b16 v[74:75], v220 offset:25088
    ds_read_b64_tr_b16 v[76:77], v221 offset:24576
    ds_read_b64_tr_b16 v[78:79], v221 offset:25088
    ds_read_b128 v[156:159], v217 offset:49152
    ds_read_b64_tr_b16 v[80:81], v220 offset:26624
    ds_read_b64_tr_b16 v[82:83], v220 offset:27136
    ds_read_b64_tr_b16 v[84:85], v221 offset:26624
    ds_read_b64_tr_b16 v[86:87], v221 offset:27136
    ds_read_b128 v[160:163], v218 offset:49152
    ds_read_b64_tr_b16 v[88:89], v220 offset:28672
    ds_read_b64_tr_b16 v[90:91], v220 offset:29184
    ds_read_b64_tr_b16 v[92:93], v221 offset:28672
    ds_read_b64_tr_b16 v[94:95], v221 offset:29184
    s_waitcnt lgkmcnt(10)
    v_mfma_f32_32x32x16_bf16 v[40:55], v[152:155], v[72:75], v[40:55]
    v_mfma_f32_32x32x16_bf16 v[56:71], v[152:155], v[76:79], v[56:71]
    ds_read_b128 v[164:167], v219 offset:49152
    ds_read_b64_tr_b16 v[96:97], v220 offset:30720
    ds_read_b64_tr_b16 v[98:99], v220 offset:31232
    ds_read_b64_tr_b16 v[100:101], v221 offset:30720
    ds_read_b64_tr_b16 v[102:103], v221 offset:31232
    s_waitcnt lgkmcnt(10)
    v_mfma_f32_32x32x16_bf16 v[40:55], v[156:159], v[80:83], v[40:55]
    v_mfma_f32_32x32x16_bf16 v[56:71], v[156:159], v[84:87], v[56:71]
    s_waitcnt lgkmcnt(5)
    v_mfma_f32_32x32x16_bf16 v[40:55], v[160:163], v[88:91], v[40:55]
    v_mfma_f32_32x32x16_bf16 v[56:71], v[160:163], v[92:95], v[56:71]
    s_waitcnt lgkmcnt(0)
    v_mfma_f32_32x32x16_bf16 v[40:55], v[164:167], v[96:99], v[40:55]
    v_mfma_f32_32x32x16_bf16 v[56:71], v[164:167], v[100:103], v[56:71]
    s_barrier
    ds_read_b128 v[168:171], v216 offset:0
    ds_read_b64_tr_b16 v[72:73], v220 offset:32768
    ds_read_b64_tr_b16 v[74:75], v220 offset:33280
    ds_read_b64_tr_b16 v[76:77], v221 offset:32768
    ds_read_b64_tr_b16 v[78:79], v221 offset:33280
    ds_read_b128 v[172:175], v217 offset:0
    ds_read_b64_tr_b16 v[80:81], v220 offset:34816
    ds_read_b64_tr_b16 v[82:83], v220 offset:35328
    ds_read_b64_tr_b16 v[84:85], v221 offset:34816
    ds_read_b64_tr_b16 v[86:87], v221 offset:35328
    ds_read_b128 v[176:179], v218 offset:0
    ds_read_b64_tr_b16 v[88:89], v220 offset:36864
    ds_read_b64_tr_b16 v[90:91], v220 offset:37376
    ds_read_b64_tr_b16 v[92:93], v221 offset:36864
    ds_read_b64_tr_b16 v[94:95], v221 offset:37376
    s_waitcnt lgkmcnt(10)
    v_mfma_f32_32x32x16_bf16 v[40:55], v[168:171], v[72:75], v[40:55]
    v_mfma_f32_32x32x16_bf16 v[56:71], v[168:171], v[76:79], v[56:71]
    ds_read_b128 v[180:183], v219 offset:0
    ds_read_b64_tr_b16 v[96:97], v220 offset:38912
    ds_read_b64_tr_b16 v[98:99], v220 offset:39424
    ds_read_b64_tr_b16 v[100:101], v221 offset:38912
    ds_read_b64_tr_b16 v[102:103], v221 offset:39424
    s_waitcnt lgkmcnt(10)
    v_mfma_f32_32x32x16_bf16 v[40:55], v[172:175], v[80:83], v[40:55]
    v_mfma_f32_32x32x16_bf16 v[56:71], v[172:175], v[84:87], v[56:71]
    s_waitcnt lgkmcnt(5)
    v_mfma_f32_32x32x16_bf16 v[40:55], v[176:179], v[88:91], v[40:55]
    v_mfma_f32_32x32x16_bf16 v[56:71], v[176:179], v[92:95], v[56:71]
    s_waitcnt lgkmcnt(0)
    v_mfma_f32_32x32x16_bf16 v[40:55], v[180:183], v[96:99], v[40:55]
    v_mfma_f32_32x32x16_bf16 v[56:71], v[180:183], v[100:103], v[56:71]
    s_barrier
    ds_read_b128 v[184:187], v216 offset:16384
    ds_read_b64_tr_b16 v[72:73], v220 offset:40960
    ds_read_b64_tr_b16 v[74:75], v220 offset:41472
    ds_read_b64_tr_b16 v[76:77], v221 offset:40960
    ds_read_b64_tr_b16 v[78:79], v221 offset:41472
    ds_read_b128 v[188:191], v217 offset:16384
    ds_read_b64_tr_b16 v[80:81], v220 offset:43008
    ds_read_b64_tr_b16 v[82:83], v220 offset:43520
    ds_read_b64_tr_b16 v[84:85], v221 offset:43008
    ds_read_b64_tr_b16 v[86:87], v221 offset:43520
    ds_read_b128 v[192:195], v218 offset:16384
    ds_read_b64_tr_b16 v[88:89], v220 offset:45056
    ds_read_b64_tr_b16 v[90:91], v220 offset:45568
    ds_read_b64_tr_b16 v[92:93], v221 offset:45056
    ds_read_b64_tr_b16 v[94:95], v221 offset:45568
    s_waitcnt lgkmcnt(10)
    v_mfma_f32_32x32x16_bf16 v[40:55], v[184:187], v[72:75], v[40:55]
    v_mfma_f32_32x32x16_bf16 v[56:71], v[184:187], v[76:79], v[56:71]
    ds_read_b128 v[196:199], v219 offset:16384
    ds_read_b64_tr_b16 v[96:97], v220 offset:47104
    ds_read_b64_tr_b16 v[98:99], v220 offset:47616
    ds_read_b64_tr_b16 v[100:101], v221 offset:47104
    ds_read_b64_tr_b16 v[102:103], v221 offset:47616
    s_waitcnt lgkmcnt(10)
    v_mfma_f32_32x32x16_bf16 v[40:55], v[188:191], v[80:83], v[40:55]
    v_mfma_f32_32x32x16_bf16 v[56:71], v[188:191], v[84:87], v[56:71]
    s_waitcnt lgkmcnt(5)
    v_mfma_f32_32x32x16_bf16 v[40:55], v[192:195], v[88:91], v[40:55]
    v_mfma_f32_32x32x16_bf16 v[56:71], v[192:195], v[92:95], v[56:71]
    s_waitcnt lgkmcnt(0)
    v_mfma_f32_32x32x16_bf16 v[40:55], v[196:199], v[96:99], v[40:55]
    v_mfma_f32_32x32x16_bf16 v[56:71], v[196:199], v[100:103], v[56:71]
    s_barrier
    ds_read_b128 v[200:203], v216 offset:32768
    ds_read_b64_tr_b16 v[72:73], v220 offset:49152
    ds_read_b64_tr_b16 v[74:75], v220 offset:49664
    ds_read_b64_tr_b16 v[76:77], v221 offset:49152
    ds_read_b64_tr_b16 v[78:79], v221 offset:49664
    ds_read_b128 v[204:207], v217 offset:32768
    ds_read_b64_tr_b16 v[80:81], v220 offset:51200
    ds_read_b64_tr_b16 v[82:83], v220 offset:51712
    ds_read_b64_tr_b16 v[84:85], v221 offset:51200
    ds_read_b64_tr_b16 v[86:87], v221 offset:51712
    ds_read_b128 v[208:211], v218 offset:32768
    ds_read_b64_tr_b16 v[88:89], v220 offset:53248
    ds_read_b64_tr_b16 v[90:91], v220 offset:53760
    ds_read_b64_tr_b16 v[92:93], v221 offset:53248
    ds_read_b64_tr_b16 v[94:95], v221 offset:53760
    s_waitcnt lgkmcnt(10)
    v_mfma_f32_32x32x16_bf16 v[40:55], v[200:203], v[72:75], v[40:55]
    v_mfma_f32_32x32x16_bf16 v[56:71], v[200:203], v[76:79], v[56:71]
    ds_read_b128 v[212:215], v219 offset:32768
    ds_read_b64_tr_b16 v[96:97], v220 offset:55296
    ds_read_b64_tr_b16 v[98:99], v220 offset:55808
    ds_read_b64_tr_b16 v[100:101], v221 offset:55296
    ds_read_b64_tr_b16 v[102:103], v221 offset:55808
    s_waitcnt lgkmcnt(10)
    v_mfma_f32_32x32x16_bf16 v[40:55], v[204:207], v[80:83], v[40:55]
    v_mfma_f32_32x32x16_bf16 v[56:71], v[204:207], v[84:87], v[56:71]
    s_waitcnt lgkmcnt(5)
    v_mfma_f32_32x32x16_bf16 v[40:55], v[208:211], v[88:91], v[40:55]
    s_waitcnt lgkmcnt(0)
    v_mfma_f32_32x32x16_bf16 v[40:55], v[212:215], v[96:99], v[40:55]
    v_mfma_f32_32x32x16_bf16 v[56:71], v[208:211], v[92:95], v[56:71]
    v_mfma_f32_32x32x16_bf16 v[56:71], v[212:215], v[100:103], v[56:71]
L_epi:
    s_cbranch_execz L_backK
    s_nop 6
    v_cvt_pk_bf16_f32 v10, v44, v45
    v_cvt_pk_bf16_f32 v11, v46, v47
    v_cvt_pk_bf16_f32 v8, v40, v41
    v_cvt_pk_bf16_f32 v9, v42, v43
    s_mov_b64 exec, s[20:21]
    v_swap_b32 v232, v10
    v_swap_b32 v233, v11
    s_mov_b64 exec, -1
    buffer_store_dwordx4 v[8:11], v1, s[8:11], s52 offen offset:0 sc1
    v_cvt_pk_bf16_f32 v14, v52, v53
    v_cvt_pk_bf16_f32 v15, v54, v55
    v_cvt_pk_bf16_f32 v12, v48, v49
    v_cvt_pk_bf16_f32 v13, v50, v51
    s_mov_b64 exec, s[22:23]
    v_swap_b32 v232, v14
    v_swap_b32 v233, v15
    s_mov_b64 exec, -1
    buffer_store_dwordx4 v[12:15], v1, s[8:11], s52 offen offset:1024 sc1
    v_cvt_pk_bf16_f32 v18, v60, v61
    v_cvt_pk_bf16_f32 v19, v62, v63
    v_cvt_pk_bf16_f32 v16, v56, v57
    v_cvt_pk_bf16_f32 v17, v58, v59
    s_mov_b64 exec, s[24:25]
    v_swap_b32 v232, v18
    v_swap_b32 v233, v19
    s_mov_b64 exec, -1
    buffer_store_dwordx4 v[16:19], v1, s[8:11], s52 offen offset:2048 sc1
    v_cvt_pk_bf16_f32 v22, v68, v69
    v_cvt_pk_bf16_f32 v23, v70, v71
    v_cvt_pk_bf16_f32 v20, v64, v65
    v_cvt_pk_bf16_f32 v21, v66, v67
    s_mov_b64 exec, s[26:27]
    v_swap_b32 v232, v22
    v_swap_b32 v233, v23
    s_mov_b64 exec, -1
    buffer_store_dwordx4 v[20:23], v1, s[8:11], s52 offen offset:3072 sc1
    s_mov_b64 exec, s[54:55]
    buffer_store_dwordx4 v[232:235], v1, s[8:11], s53 offen sc1
    s_mov_b64 exec, -1
L_pub:
    s_add_u32 s56, s3, 4
    s_cmp_ge_u32 s56, 7
    s_cselect_b32 s26, 7, 0
    s_sub_u32 s56, s56, s26
    s_mul_i32 s26, s56, 172032
    s_add_u32 m0, s63, 16384
    s_add_u32 s26, s26, s62
    buffer_load_dwordx4 v250, s[16:19], s26 offen lds
    s_add_u32 s56, s56, 1
    s_cmp_eq_u32 s56, 7
    s_cselect_b32 s56, 0, s56
    s_mul_i32 s26, s56, 172032
    s_add_u32 m0, s63, 20480
    s_add_u32 s26, s26, s62
    buffer_load_dwordx4 v250, s[16:19], s26 offen lds
    s_add_u32 s56, s56, 1
    s_cmp_eq_u32 s56, 7
    s_cselect_b32 s56, 0, s56
    s_mul_i32 s26, s56, 172032
    s_add_u32 m0, s63, 24576
    s_add_u32 s26, s26, s62
    buffer_load_dwordx4 v250, s[16:19], s26 offen lds
    s_mov_b64 s[16:17], s[36:37]
    s_mov_b32 s18, 4587520
    s_mov_b32 s57, 0
    s_mov_b32 s60, 1048576
Lsp_1:
    ds_read_b32 v4, v223 offset:0
    s_sub_u32 s60, s60, 1
    s_cbranch_scc1 L_exit
    s_waitcnt lgkmcnt(0)
    v_readfirstlane_b32 s61, v4
    s_cmp_ge_u32 s61, 4
    s_cbranch_scc0 Lsp_1
    ds_read_b32 v11, v223 offset:44
    ds_read_b64_tr_b16 v[72:73], v222 offset:0
    ds_read_b64_tr_b16 v[74:75], v222 offset:256
    ds_read_b64_tr_b16 v[76:77], v222 offset:1024
    ds_read_b64_tr_b16 v[78:79], v222 offset:1280
    ds_read_b64_tr_b16 v[80:81], v222 offset:2048
    ds_read_b64_tr_b16 v[82:83], v222 offset:2304
    ds_read_b64_tr_b16 v[84:85], v222 offset:3072
    ds_read_b64_tr_b16 v[86:87], v222 offset:3328
    ds_read_b64_tr_b16 v[88:89], v222 offset:4096
    ds_read_b64_tr_b16 v[90:91], v222 offset:4352
    ds_read_b64_tr_b16 v[92:93], v222 offset:5120
    ds_read_b64_tr_b16 v[94:95], v222 offset:5376
    ds_read_b64_tr_b16 v[96:97], v222 offset:6144
    ds_read_b64_tr_b16 v[98:99], v222 offset:6400
    s_waitcnt lgkmcnt(12)
    v_mfma_f32_32x32x16_bf16 v[40:55], v[72:75], v[104:107], 0
    ds_read_b64_tr_b16 v[100:101], v222 offset:7168
    ds_read_b64_tr_b16 v[102:103], v222 offset:7424
    s_waitcnt lgkmcnt(12)
    v_mfma_f32_32x32x16_bf16 v[40:55], v[76:79], v[108:111], v[40:55]
    ds_read_b64_tr_b16 v[72:73], v222 offset:8192
    ds_read_b64_tr_b16 v[74:75], v222 offset:8448
    s_waitcnt lgkmcnt(12)
    v_mfma_f32_32x32x16_bf16 v[40:55], v[80:83], v[112:115], v[40:55]
    ds_read_b64_tr_b16 v[76:77], v222 offset:9216
    ds_read_b64_tr_b16 v[78:79], v222 offset:9472
    s_waitcnt lgkmcnt(12)
    v_mfma_f32_32x32x16_bf16 v[40:55], v[84:87], v[116:119], v[40:55]
    ds_read_b64_tr_b16 v[80:81], v222 offset:10240
    ds_read_b64_tr_b16 v[82:83], v222 offset:10496
    s_waitcnt lgkmcnt(12)
    v_mfma_f32_32x32x16_bf16 v[40:55], v[88:91], v[120:123], v[40:55]
    ds_read_b64_tr_b16 v[84:85], v222 offset:11264
    ds_read_b64_tr_b16 v[86:87], v222 offset:11520
    s_waitcnt lgkmcnt(12)
    v_mfma_f32_32x32x16_bf16 v[40:55], v[92:95], v[124:127], v[40:55]
    ds_read_b64_tr_b16 v[88:89], v222 offset:12288
    ds_read_b64_tr_b16 v[90:91], v222 offset:12544
    s_waitcnt lgkmcnt(12)
    v_mfma_f32_32x32x16_bf16 v[40:55], v[96:99], v[128:131], v[40:55]
    ds_read_b64_tr_b16 v[92:93], v222 offset:13312
    ds_read_b64_tr_b16 v[94:95], v222 offset:13568
    s_waitcnt lgkmcnt(12)
    v_mfma_f32_32x32x16_bf16 v[40:55], v[100:103], v[132:135], v[40:55]
    ds_read_b64_tr_b16 v[96:97], v222 offset:14336
    ds_read_b64_tr_b16 v[98:99], v222 offset:14592
    s_waitcnt lgkmcnt(12)
    v_mfma_f32_32x32x16_bf16 v[40:55], v[72:75], v[136:139], v[40:55]
    ds_read_b64_tr_b16 v[100:101], v222 offset:15360
    ds_read_b64_tr_b16 v[102:103], v222 offset:15616
    s_waitcnt lgkmcnt(12)
    v_mfma_f32_32x32x16_bf16 v[40:55], v[76:79], v[140:143], v[40:55]
    s_waitcnt lgkmcnt(10)
    v_mfma_f32_32x32x16_bf16 v[40:55], v[80:83], v[144:147], v[40:55]
    s_waitcnt lgkmcnt(8)
    v_mfma_f32_32x32x16_bf16 v[40:55], v[84:87], v[148:151], v[40:55]
    s_waitcnt lgkmcnt(6)
    v_mfma_f32_32x32x16_bf16 v[40:55], v[88:91], v[152:155], v[40:55]
    s_waitcnt lgkmcnt(4)
    v_mfma_f32_32x32x16_bf16 v[40:55], v[92:95], v[156:159], v[40:55]
    s_waitcnt lgkmcnt(2)
    v_mfma_f32_32x32x16_bf16 v[40:55], v[96:99], v[160:163], v[40:55]
    s_waitcnt lgkmcnt(0)
    v_mfma_f32_32x32x16_bf16 v[40:55], v[100:103], v[164:167], v[40:55]
    s_mov_b32 s28, 6914048
    v_readfirstlane_b32 s30, v11
    v_mov_b32 v6, v11
    s_mov_b64 exec, 1
    s_waitcnt vmcnt(3)
    ds_add_rtn_u32 v4, v223, v224 offset:20
    s_waitcnt lgkmcnt(0)
    v_cmp_eq_u32 vcc, 3, v4
    s_cbranch_vccz L_notlast
    s_mov_b64 exec, s[64:65]
    s_cbranch_execz L_notlast
    buffer_atomic_swap v6, v252, s[8:11], s28 offen sc1
    s_waitcnt vmcnt(1)
    s_branch L_published
L_notlast:
    s_waitcnt vmcnt(0)
    s_cmp_lg_u32 s34, 14
    s_cbranch_scc1 L_published
    s_mov_b32 s26, 6832128
    s_mov_b32 exec_lo, -1
    buffer_store_dwordx2 v[10:11], v9, s[8:11], s26 offen sc1
L_published:
    s_mov_b64 exec, -1
    s_mov_b64 exec, 1
    ds_add_u32 v223, v224 offset:4
    s_mov_b64 exec, -1
    s_cmp_eq_u32 s57, 2
    s_cbranch_scc1 Ltl_3
    ds_read_b32 v4, v251 offset:64
    ds_read_b32 v5, v223 offset:88
    s_cmp_eq_u32 s57, 1
    s_waitcnt lgkmcnt(0)
    v_readfirstlane_b32 s56, v4
    s_cbranch_scc1 Ltg_5
    v_readfirstlane_b32 s29, v5
    s_sub_u32 s29, s29, 1
    s_cbranch_scc1 Ltl_3
    s_mov_b32 s57, 1
    s_nop 1
    buffer_load_dwordx4 v[232:235], v228, s[16:19], s29 offen sc1
    buffer_load_dwordx4 v[236:239], v229, s[16:19], s29 offen sc1
Ltg_5:
    s_sub_u32 s27, s56, 1
    s_cbranch_scc1 Ltl_3
    s_add_u32 s54, s56, 71679
    s_add_u32 s55, s56, 143359
    s_add_u32 s56, s56, 215039
    s_mov_b32 s57, 2
    buffer_load_dwordx4 v[104:107], v228, s[16:19], s27 offen sc1
    buffer_load_dwordx4 v[108:111], v229, s[16:19], s27 offen sc1
    buffer_load_dwordx4 v[112:115], v230, s[16:19], s27 offen sc1
    buffer_load_dwordx4 v[116:119], v231, s[16:19], s27 offen sc1
    buffer_load_dwordx4 v[120:123], v228, s[16:19], s54 offen sc1
    buffer_load_dwordx4 v[124:127], v229, s[16:19], s54 offen sc1
    buffer_load_dwordx4 v[128:131], v230, s[16:19], s54 offen sc1
    buffer_load_dwordx4 v[132:135], v231, s[16:19], s54 offen sc1
Ltl_3:
    s_mov_b32 s60, 1048576
Lsp_6:
    ds_read_b32 v4, v223 offset:4
    s_sub_u32 s60, s60, 1
    s_cbranch_scc1 L_exit
    s_waitcnt lgkmcnt(0)
    v_readfirstlane_b32 s61, v4
    s_cmp_ge_u32 s61, 4
    s_cbranch_scc0 Lsp_6
    ds_read_b64_tr_b16 v[72:73], v222 offset:16384
    ds_read_b64_tr_b16 v[74:75], v222 offset:16640
    ds_read_b64_tr_b16 v[76:77], v222 offset:17408
    ds_read_b64_tr_b16 v[78:79], v222 offset:17664
    ds_read_b64_tr_b16 v[80:81], v222 offset:18432
    ds_read_b64_tr_b16 v[82:83], v222 offset:18688
    ds_read_b64_tr_b16 v[84:85], v222 offset:19456
    ds_read_b64_tr_b16 v[86:87], v222 offset:19712
    ds_read_b64_tr_b16 v[88:89], v222 offset:20480
    ds_read_b64_tr_b16 v[90:91], v222 offset:20736
    ds_read_b64_tr_b16 v[92:93], v222 offset:21504
    ds_read_b64_tr_b16 v[94:95], v222 offset:21760
    ds_read_b64_tr_b16 v[96:97], v222 offset:22528
    ds_read_b64_tr_b16 v[98:99], v222 offset:22784
    s_waitcnt lgkmcnt(12)
    v_mfma_f32_32x32x16_bf16 v[40:55], v[72:75], v[168:171], v[40:55]
    ds_read_b64_tr_b16 v[100:101], v222 offset:23552
    ds_read_b64_tr_b16 v[102:103], v222 offset:23808
    s_waitcnt lgkmcnt(12)
    v_mfma_f32_32x32x16_bf16 v[40:55], v[76:79], v[172:175], v[40:55]
    ds_read_b64_tr_b16 v[72:73], v222 offset:24576
    ds_read_b64_tr_b16 v[74:75], v222 offset:24832
    s_waitcnt lgkmcnt(12)
    v_mfma_f32_32x32x16_bf16 v[40:55], v[80:83], v[176:179], v[40:55]
    ds_read_b64_tr_b16 v[76:77], v222 offset:25600
    ds_read_b64_tr_b16 v[78:79], v222 offset:25856
    s_waitcnt lgkmcnt(12)
    v_mfma_f32_32x32x16_bf16 v[40:55], v[84:87], v[180:183], v[40:55]
    ds_read_b64_tr_b16 v[80:81], v222 offset:26624
    ds_read_b64_tr_b16 v[82:83], v222 offset:26880
    s_waitcnt lgkmcnt(12)
    v_mfma_f32_32x32x16_bf16 v[40:55], v[88:91], v[184:187], v[40:55]
    ds_read_b64_tr_b16 v[84:85], v222 offset:27648
    ds_read_b64_tr_b16 v[86:87], v222 offset:27904
    s_waitcnt lgkmcnt(12)
    v_mfma_f32_32x32x16_bf16 v[40:55], v[92:95], v[188:191], v[40:55]
    s_waitcnt lgkmcnt(10)
    v_mfma_f32_32x32x16_bf16 v[40:55], v[96:99], v[192:195], v[40:55]
    s_waitcnt lgkmcnt(8)
    v_mfma_f32_32x32x16_bf16 v[40:55], v[100:103], v[196:199], v[40:55]
    s_waitcnt lgkmcnt(6)
    v_mfma_f32_32x32x16_bf16 v[40:55], v[72:75], v[200:203], v[40:55]
    s_waitcnt lgkmcnt(4)
    v_mfma_f32_32x32x16_bf16 v[40:55], v[76:79], v[204:207], v[40:55]
    s_waitcnt lgkmcnt(2)
    v_mfma_f32_32x32x16_bf16 v[40:55], v[80:83], v[208:211], v[40:55]
    s_waitcnt lgkmcnt(0)
    v_mfma_f32_32x32x16_bf16 v[40:55], v[84:87], v[212:215], v[40:55]
    s_cmp_eq_u32 s57, 2
    s_cbranch_scc1 Ltl_8
    ds_read_b32 v4, v251 offset:64
    ds_read_b32 v5, v223 offset:88
    s_cmp_eq_u32 s57, 1
    s_waitcnt lgkmcnt(0)
    v_readfirstlane_b32 s56, v4
    s_cbranch_scc1 Ltg_10
    v_readfirstlane_b32 s29, v5
    s_sub_u32 s29, s29, 1
    s_cbranch_scc1 Ltl_8
    s_mov_b32 s57, 1
    s_nop 1
    buffer_load_dwordx4 v[232:235], v228, s[16:19], s29 offen sc1
    buffer_load_dwordx4 v[236:239], v229, s[16:19], s29 offen sc1
Ltg_10:
    s_sub_u32 s27, s56, 1
    s_cbranch_scc1 Ltl_8
    s_add_u32 s54, s56, 71679
    s_add_u32 s55, s56, 143359
    s_add_u32 s56, s56, 215039
    s_mov_b32 s57, 2
    buffer_load_dwordx4 v[104:107], v228, s[16:19], s27 offen sc1
    buffer_load_dwordx4 v[108:111], v229, s[16:19], s27 offen sc1
    buffer_load_dwordx4 v[112:115], v230, s[16:19], s27 offen sc1
    buffer_load_dwordx4 v[116:119], v231, s[16:19], s27 offen sc1
    buffer_load_dwordx4 v[120:123], v228, s[16:19], s54 offen sc1
    buffer_load_dwordx4 v[124:127], v229, s[16:19], s54 offen sc1
    buffer_load_dwordx4 v[128:131], v230, s[16:19], s54 offen sc1
    buffer_load_dwordx4 v[132:135], v231, s[16:19], s54 offen sc1
Ltl_8:
    v_mov_b32 v160, 0
    v_mov_b32 v161, 0
    v_mov_b32 v162, 0
    v_mov_b32 v163, 0
    v_mov_b32 v164, 0
    v_mov_b32 v165, 0
    v_mov_b32 v166, 0
    v_mov_b32 v167, 0
    s_lshl_b32 s26, s33, 11
    s_add_u32 s26, s26, 151552
    v_add_u32 v5, s26, v1
    s_mov_b32 s62, 0x3e8b97f6
    s_mov_b32 s63, 0x3e8b97f6
    v_pk_mul_f32 v[40:41], v[40:41], s[62:63]
    v_pk_mul_f32 v[42:43], v[42:43], s[62:63]
    v_pk_mul_f32 v[44:45], v[44:45], s[62:63]
    v_pk_mul_f32 v[46:47], v[46:47], s[62:63]
    v_pk_mul_f32 v[48:49], v[48:49], s[62:63]
    v_pk_mul_f32 v[50:51], v[50:51], s[62:63]
    v_pk_mul_f32 v[52:53], v[52:53], s[62:63]
    v_pk_mul_f32 v[54:55], v[54:55], s[62:63]
    v_cvt_pk_bf16_f32 v32, v40, v41
    v_cvt_pk_bf16_f32 v33, v42, v43
    v_cvt_pk_bf16_f32 v34, v44, v45
    v_cvt_pk_bf16_f32 v35, v46, v47
    v_cvt_pk_bf16_f32 v36, v48, v49
    v_cvt_pk_bf16_f32 v37, v50, v51
    v_cvt_pk_bf16_f32 v38, v52, v53
    v_cvt_pk_bf16_f32 v39, v54, v55
    s_mov_b32 exec_lo, 0
    v_mov_b32 v38, 0
    v_mov_b32 v39, 0
    s_mov_b32 exec_lo, -1
    ds_write_b128 v5, v[32:35]
    ds_write_b128 v5, v[36:39] offset:1024
    s_mov_b64 exec, 1
    ds_add_u32 v223, v224 offset:8
    s_mov_b64 exec, -1
    v_pk_mul_f32 v[40:41], v[160:161], v[160:161]
    v_pk_mul_f32 v[42:43], v[160:161], v[160:161]
    v_pk_mul_f32 v[44:45], v[160:161], v[160:161]
    v_pk_mul_f32 v[46:47], v[160:161], v[160:161]
    v_pk_mul_f32 v[48:49], v[160:161], v[160:161]
    v_pk_mul_f32 v[50:51], v[160:161], v[160:161]
    v_pk_mul_f32 v[52:53], v[160:161], v[160:161]
    v_pk_mul_f32 v[54:55], v[160:161], v[160:161]
    v_pk_mul_f32 v[56:57], v[160:161], v[160:161]
    v_pk_mul_f32 v[58:59], v[160:161], v[160:161]
    v_pk_mul_f32 v[60:61], v[160:161], v[160:161]
    v_pk_mul_f32 v[62:63], v[160:161], v[160:161]
    v_pk_mul_f32 v[64:65], v[160:161], v[160:161]
    v_pk_mul_f32 v[66:67], v[160:161], v[160:161]
    v_pk_mul_f32 v[68:69], v[160:161], v[160:161]
    v_pk_mul_f32 v[70:71], v[160:161], v[160:161]
    v_pk_mul_f32 v[72:73], v[160:161], v[160:161]
    v_pk_mul_f32 v[74:75], v[160:161], v[160:161]
    v_pk_mul_f32 v[76:77], v[160:161], v[160:161]
    v_pk_mul_f32 v[78:79], v[160:161], v[160:161]
    v_pk_mul_f32 v[80:81], v[160:161], v[160:161]
    v_pk_mul_f32 v[82:83], v[160:161], v[160:161]
    v_pk_mul_f32 v[84:85], v[160:161], v[160:161]
    v_pk_mul_f32 v[86:87], v[160:161], v[160:161]
    s_mov_b32 s60, 1048576
Lsp_11:
    ds_read_b32 v4, v223 offset:8
    s_sub_u32 s60, s60, 1
    s_cbranch_scc1 L_exit
    s_waitcnt lgkmcnt(0)
    v_readfirstlane_b32 s61, v4
    s_cmp_ge_u32 s61, 4
    s_cbranch_scc0 Lsp_11
    s_add_u32 s26, s33, 1
    s_and_b32 s26, s26, 3
    s_lshl_b32 s26, s26, 11
    s_add_u32 s26, s26, 151552
    v_add_u32 v5, s26, v1
    ds_read_b128 v[8:11], v5
    ds_read_b128 v[12:15], v5 offset:1024
    s_add_u32 s26, s33, 2
    s_and_b32 s26, s26, 3
    s_lshl_b32 s26, s26, 11
    s_add_u32 s26, s26, 151552
    v_add_u32 v5, s26, v1
    ds_read_b128 v[16:19], v5
    ds_read_b128 v[20:23], v5 offset:1024
    s_add_u32 s26, s33, 3
    s_and_b32 s26, s26, 3
    s_lshl_b32 s26, s26, 11
    s_add_u32 s26, s26, 151552
    v_add_u32 v5, s26, v1
    ds_read_b128 v[24:27], v5
    ds_read_b128 v[28:31], v5 offset:1024
    s_add_u32 s26, s33, 1
    s_and_b32 s26, s26, 3
    s_mul_i32 s26, s26, 12288
    s_add_u32 s26, s26, 102400
    v_add_u32 v216, s26, v1
    s_add_u32 s26, s33, 2
    s_and_b32 s26, s26, 3
    s_mul_i32 s26, s26, 12288
    s_add_u32 s26, s26, 106496
    v_add_u32 v217, s26, v1
    s_add_u32 s26, s33, 3
    s_and_b32 s26, s26, 3
    s_mul_i32 s26, s26, 12288
    s_add_u32 s26, s26, 110592
    v_add_u32 v218, s26, v1
    s_mul_i32 s26, s33, 12288
    s_add_u32 s26, s26, 102400
    v_add_u32 v2, s26, v1
    v_mov_b32 v219, 0xdddddddd
    s_cmp_eq_u32 s57, 2
    s_cbranch_scc1 Ltl_13
    s_mov_b32 s60, 1048576
Ltr_14:
    s_sub_u32 s60, s60, 1
    s_cbranch_scc1 L_exit
    ds_read_b32 v4, v251 offset:64
    ds_read_b32 v5, v223 offset:88
    s_cmp_eq_u32 s57, 1
    s_waitcnt lgkmcnt(0)
    v_readfirstlane_b32 s56, v4
    s_cbranch_scc1 Ltg_15
    v_readfirstlane_b32 s29, v5
    s_sub_u32 s29, s29, 1
    s_cbranch_scc1 Ltr_14
    s_mov_b32 s57, 1
    s_nop 1
    buffer_load_dwordx4 v[232:235], v228, s[16:19], s29 offen sc1
    buffer_load_dwordx4 v[236:239], v229, s[16:19], s29 offen sc1
Ltg_15:
    s_sub_u32 s27, s56, 1
    s_cbranch_scc1 Ltr_14
    s_add_u32 s54, s56, 71679
    s_add_u32 s55, s56, 143359
    s_add_u32 s56, s56, 215039
    s_mov_b32 s57, 2
    buffer_load_dwordx4 v[104:107], v228, s[16:19], s27 offen sc1
    buffer_load_dwordx4 v[108:111], v229, s[16:19], s27 offen sc1
    buffer_load_dwordx4 v[112:115], v230, s[16:19], s27 offen sc1
    buffer_load_dwordx4 v[116:119], v231, s[16:19], s27 offen sc1
    buffer_load_dwordx4 v[120:123], v228, s[16:19], s54 offen sc1
    buffer_load_dwordx4 v[124:127], v229, s[16:19], s54 offen sc1
    buffer_load_dwordx4 v[128:131], v230, s[16:19], s54 offen sc1
    buffer_load_dwordx4 v[132:135], v231, s[16:19], s54 offen sc1
Ltl_13:
    s_waitcnt vmcnt(8) lgkmcnt(0)
    v_mfma_f32_32x32x16_bf16 v[200:215], v[232:235], v[8:11], 0
    v_mfma_f32_32x32x16_bf16 v[200:215], v[236:239], v[12:15], v[200:215]
    v_mfma_f32_32x32x16_bf16 v[168:183], v[232:235], v[24:27], 0
    v_mfma_f32_32x32x16_bf16 v[168:183], v[236:239], v[28:31], v[168:183]
    v_mfma_f32_32x32x16_bf16 v[184:199], v[232:235], v[16:19], 0
    v_mfma_f32_32x32x16_bf16 v[184:199], v[236:239], v[20:23], v[184:199]
    s_nop 3
    v_max3_f32 v4, v200, v201, v202
    v_max3_f32 v4, v4, v203, v204
    v_max3_f32 v4, v4, v205, v206
    v_max3_f32 v4, v4, v207, v208
    v_max3_f32 v4, v4, v209, v210
    v_max3_f32 v4, v4, v211, v212
    v_max3_f32 v4, v4, v213, v214
    v_max_f32 v4, v4, v215
    s_mov_b32 exec_lo, 0
    v_cvt_pk_bf16_f32 v14, -v4, 0
    s_mov_b32 exec_lo, -1
    v_mfma_f32_32x32x16_bf16 v[88:103], v[232:235], v[32:35], 0
    v_mfma_f32_32x32x16_bf16 v[88:103], v[236:239], v[36:39], v[88:103]
    v_max3_f32 v4, v168, v169, v170
    v_max3_f32 v4, v4, v171, v172
    v_max3_f32 v4, v4, v173, v174
    v_max3_f32 v4, v4, v175, v176
    v_max3_f32 v4, v4, v177, v178
    v_max3_f32 v4, v4, v179, v180
    v_max3_f32 v4, v4, v181, v182
    v_max_f32 v4, v4, v183
    s_mov_b32 exec_lo, 0
    v_cvt_pk_bf16_f32 v30, -v4, 0
    s_mov_b32 exec_lo, -1
    s_waitcnt vmcnt(6)
    v_mfma_f32_32x32x16_bf16 v[168:183], v[104:107], v[8:11], 0
    v_mfma_f32_32x32x16_bf16 v[168:183], v[108:111], v[12:15], v[168:183]
    buffer_load_dwordx4 v[136:139], v228, s[16:19], s55 offen sc1
    buffer_load_dwordx4 v[140:143], v229, s[16:19], s55 offen sc1
    buffer_load_dwordx4 v[144:147], v230, s[16:19], s55 offen sc1
    buffer_load_dwordx4 v[148:151], v231, s[16:19], s55 offen sc1
    buffer_load_dwordx4 v[152:155], v228, s[16:19], s56 offen sc1
    buffer_load_dwordx4 v[156:159], v229, s[16:19], s56 offen sc1
    v_max3_f32 v4, v184, v185, v186
    v_max3_f32 v4, v4, v187, v188
    v_max3_f32 v4, v4, v189, v190
    v_max3_f32 v4, v4, v191, v192
    v_max3_f32 v4, v4, v193, v194
    v_max3_f32 v4, v4, v195, v196
    v_max3_f32 v4, v4, v197, v198
    v_max_f32 v4, v4, v199
    s_mov_b32 exec_lo, 0
    v_cvt_pk_bf16_f32 v22, -v4, 0
    s_mov_b32 exec_lo, -1
    v_pk_mul_f32 v[192:193], v[160:161], v[160:161]
    v_pk_mul_f32 v[194:195], v[160:161], v[160:161]
    v_pk_mul_f32 v[196:197], v[160:161], v[160:161]
    v_pk_mul_f32 v[198:199], v[160:161], v[160:161]
    v_max3_f32 v4, v88, v89, v90
    v_max3_f32 v4, v4, v91, v92
    v_max3_f32 v4, v4, v93, v94
    v_max3_f32 v4, v4, v95, v96
    v_max3_f32 v4, v4, v97, v98
    v_max3_f32 v4, v4, v99, v100
    v_max3_f32 v4, v4, v101, v102
    v_max_f32 v4, v4, v103
    s_mov_b32 exec_lo, 0
    v_cvt_pk_bf16_f32 v38, -v4, 0
    s_mov_b32 exec_lo, -1
    v_pk_mul_f32 v[88:89], v[160:161], v[160:161]
    v_pk_mul_f32 v[90:91], v[160:161], v[160:161]
    v_pk_mul_f32 v[92:93], v[160:161], v[160:161]
    v_pk_mul_f32 v[94:95], v[160:161], v[160:161]
    v_pk_mul_f32 v[96:97], v[160:161], v[160:161]
    v_pk_mul_f32 v[98:99], v[160:161], v[160:161]
    v_pk_mul_f32 v[100:101], v[160:161], v[160:161]
    v_pk_mul_f32 v[102:103], v[160:161], v[160:161]
    s_mov_b32 s57, 2
    s_mov_b32 s53, 6832128
    s_waitcnt vmcnt(10)
.p2align 6
L_loop:
    v_exp_f32 v168, v168
    v_exp_f32 v169, v169
    v_smfmac_f32_32x32x32_bf16 v[88:103], v[164:167], v[192:199], v219
    buffer_load_dwordx4 v[160:163], v230, s[16:19], s56 offen sc1
    v_exp_f32 v170, v170
    v_exp_f32 v171, v171
    v_exp_f32 v172, v172
    v_mfma_f32_32x32x16_bf16 v[184:199], v[104:107], v[16:19], 0
    ds_read_b32 v7, v251 offset:68
    v_exp_f32 v173, v173
    v_exp_f32 v174, v174
    v_exp_f32 v175, v175
    v_mfma_f32_32x32x16_bf16 v[184:199], v[108:111], v[20:23], v[184:199]
    v_exp_f32 v176, v176
    v_exp_f32 v177, v177
    v_exp_f32 v178, v178
    v_exp_f32 v179, v179
    v_exp_f32 v180, v180
    v_exp_f32 v181, v181
    v_smfmac_f32_32x32x32_bf16 v[40:55], v[112:115], v[168:175], v219
    buffer_load_dwordx4 v[164:167], v231, s[16:19], s56 offen sc1
    v_exp_f32 v182, v182
    v_exp_f32 v183, v183
    v_exp_f32 v184, v184
    v_exp_f32 v185, v185
    v_smfmac_f32_32x32x32_bf16 v[40:55], v[116:119], v[176:183], v219
    s_waitcnt lgkmcnt(0)
    v_readfirstlane_b32 s56, v7
    v_exp_f32 v186, v186
    v_exp_f32 v187, v187
    v_exp_f32 v188, v188
    v_mfma_f32_32x32x16_bf16 v[168:183], v[104:107], v[24:27], 0
    s_sub_u32 s56, s56, 1
    v_exp_f32 v189, v189
    v_exp_f32 v190, v190
    v_exp_f32 v191, v191
    v_mfma_f32_32x32x16_bf16 v[168:183], v[108:111], v[28:31], v[168:183]
    s_cbranch_scc1 L_nextwait
L_nextok:
    v_add_u32 v251, 4, v251
    v_exp_f32 v192, v192
    v_exp_f32 v193, v193
    v_exp_f32 v194, v194
    v_exp_f32 v195, v195
    v_exp_f32 v196, v196
    v_exp_f32 v197, v197
    v_smfmac_f32_32x32x32_bf16 v[56:71], v[112:115], v[184:191], v219
    v_exp_f32 v198, v198
    v_exp_f32 v199, v199
    v_exp_f32 v168, v168
    v_exp_f32 v169, v169
    v_smfmac_f32_32x32x32_bf16 v[56:71], v[116:119], v[192:199], v219
    v_exp_f32 v170, v170
    v_exp_f32 v171, v171
    v_exp_f32 v172, v172
    v_mfma_f32_32x32x16_bf16 v[184:199], v[104:107], v[32:35], 0
    v_exp_f32 v173, v173
    v_exp_f32 v174, v174
    v_exp_f32 v175, v175
    v_mfma_f32_32x32x16_bf16 v[184:199], v[108:111], v[36:39], v[184:199]
    ds_add_u32 v223, v224 offset:92
    v_exp_f32 v176, v176
    v_exp_f32 v177, v177
    v_exp_f32 v178, v178
    v_exp_f32 v179, v179
    v_exp_f32 v180, v180
    v_exp_f32 v181, v181
    v_smfmac_f32_32x32x32_bf16 v[72:87], v[112:115], v[168:175], v219
    s_waitcnt vmcnt(10)
    v_exp_f32 v182, v182
    v_exp_f32 v183, v183
    v_exp_f32 v184, v184
    v_exp_f32 v185, v185
    v_smfmac_f32_32x32x32_bf16 v[72:87], v[116:119], v[176:183], v219
    buffer_load_dwordx4 v[104:107], v228, s[16:19], s56 offen sc1
    v_exp_f32 v186, v186
    v_exp_f32 v187, v187
    v_exp_f32 v188, v188
    v_mfma_f32_32x32x16_bf16 v[168:183], v[120:123], v[8:11], 0
    v_exp_f32 v189, v189
    v_exp_f32 v190, v190
    v_exp_f32 v191, v191
    v_mfma_f32_32x32x16_bf16 v[168:183], v[124:127], v[12:15], v[168:183]
    v_exp_f32 v192, v192
    v_exp_f32 v193, v193
    v_exp_f32 v194, v194
    v_exp_f32 v195, v195
    v_exp_f32 v196, v196
    v_exp_f32 v197, v197
    v_smfmac_f32_32x32x32_bf16 v[88:103], v[112:115], v[184:191], v219
    buffer_load_dwordx4 v[108:111], v229, s[16:19], s56 offen sc1
    s_waitcnt vmcnt(10)
    v_exp_f32 v198, v198
    v_exp_f32 v199, v199
    v_exp_f32 v168, v168
    v_exp_f32 v169, v169
    v_smfmac_f32_32x32x32_bf16 v[88:103], v[116:119], v[192:199], v219
    buffer_load_dwordx4 v[112:115], v230, s[16:19], s56 offen sc1
    v_exp_f32 v170, v170
    v_exp_f32 v171, v171
    v_exp_f32 v172, v172
    v_mfma_f32_32x32x16_bf16 v[184:199], v[120:123], v[16:19], 0
    v_exp_f32 v173, v173
    v_exp_f32 v174, v174
    v_exp_f32 v175, v175
    v_mfma_f32_32x32x16_bf16 v[184:199], v[124:127], v[20:23], v[184:199]
    v_exp_f32 v176, v176
    v_exp_f32 v177, v177
    v_exp_f32 v178, v178
    v_exp_f32 v179, v179
    v_exp_f32 v180, v180
    v_exp_f32 v181, v181
    v_smfmac_f32_32x32x32_bf16 v[40:55], v[128:131], v[168:175], v219
    buffer_load_dwordx4 v[116:119], v231, s[16:19], s56 offen sc1
    v_exp_f32 v182, v182
    v_exp_f32 v183, v183
    v_exp_f32 v184, v184
    v_exp_f32 v185, v185
    v_smfmac_f32_32x32x32_bf16 v[40:55], v[132:135], v[176:183], v219
    v_exp_f32 v186, v186
    v_exp_f32 v187, v187
    v_exp_f32 v188, v188
    v_mfma_f32_32x32x16_bf16 v[168:183], v[120:123], v[24:27], 0
    s_add_u32 s56, s56, 71680
    v_exp_f32 v189, v189
    v_exp_f32 v190, v190
    v_exp_f32 v191, v191
    v_mfma_f32_32x32x16_bf16 v[168:183], v[124:127], v[28:31], v[168:183]
    v_exp_f32 v192, v192
    v_exp_f32 v193, v193
    v_exp_f32 v194, v194
    v_exp_f32 v195, v195
    v_exp_f32 v196, v196
    v_exp_f32 v197, v197
    v_smfmac_f32_32x32x32_bf16 v[56:71], v[128:131], v[184:191], v219
    v_exp_f32 v198, v198
    v_exp_f32 v199, v199
    v_exp_f32 v168, v168
    v_exp_f32 v169, v169
    v_smfmac_f32_32x32x32_bf16 v[56:71], v[132:135], v[192:199], v219
    v_exp_f32 v170, v170
    v_exp_f32 v171, v171
    v_exp_f32 v172, v172
    v_mfma_f32_32x32x16_bf16 v[184:199], v[120:123], v[32:35], 0
    v_exp_f32 v173, v173
    v_exp_f32 v174, v174
    v_exp_f32 v175, v175
    v_mfma_f32_32x32x16_bf16 v[184:199], v[124:127], v[36:39], v[184:199]
    v_exp_f32 v176, v176
    v_exp_f32 v177, v177
    v_exp_f32 v178, v178
    v_exp_f32 v179, v179
    v_exp_f32 v180, v180
    v_exp_f32 v181, v181
    v_smfmac_f32_32x32x32_bf16 v[72:87], v[128:131], v[168:175], v219
    s_waitcnt vmcnt(10)
    v_exp_f32 v182, v182
    v_exp_f32 v183, v183
    v_exp_f32 v184, v184
    v_exp_f32 v185, v185
    v_smfmac_f32_32x32x32_bf16 v[72:87], v[132:135], v[176:183], v219
    buffer_load_dwordx4 v[120:123], v228, s[16:19], s56 offen sc1
    v_exp_f32 v186, v186
    v_exp_f32 v187, v187
    v_exp_f32 v188, v188
    v_mfma_f32_32x32x16_bf16 v[168:183], v[136:139], v[8:11], 0
    v_exp_f32 v189, v189
    v_exp_f32 v190, v190
    v_exp_f32 v191, v191
    v_mfma_f32_32x32x16_bf16 v[168:183], v[140:143], v[12:15], v[168:183]
    v_exp_f32 v192, v192
    v_exp_f32 v193, v193
    v_exp_f32 v194, v194
    v_exp_f32 v195, v195
    v_exp_f32 v196, v196
    v_exp_f32 v197, v197
    v_smfmac_f32_32x32x32_bf16 v[88:103], v[128:131], v[184:191], v219
    buffer_load_dwordx4 v[124:127], v229, s[16:19], s56 offen sc1
    s_waitcnt vmcnt(10)
    v_exp_f32 v198, v198
    v_exp_f32 v199, v199
    v_exp_f32 v168, v168
    v_exp_f32 v169, v169
    v_smfmac_f32_32x32x32_bf16 v[88:103], v[132:135], v[192:199], v219
    buffer_load_dwordx4 v[128:131], v230, s[16:19], s56 offen sc1
    v_exp_f32 v170, v170
    v_exp_f32 v171, v171
    v_exp_f32 v172, v172
    v_mfma_f32_32x32x16_bf16 v[184:199], v[136:139], v[16:19], 0
    v_exp_f32 v173, v173
    v_exp_f32 v174, v174
    v_exp_f32 v175, v175
    v_mfma_f32_32x32x16_bf16 v[184:199], v[140:143], v[20:23], v[184:199]
    v_exp_f32 v176, v176
    v_exp_f32 v177, v177
    v_exp_f32 v178, v178
    v_exp_f32 v179, v179
    v_exp_f32 v180, v180
    v_exp_f32 v181, v181
    v_smfmac_f32_32x32x32_bf16 v[40:55], v[144:147], v[168:175], v219
    buffer_load_dwordx4 v[132:135], v231, s[16:19], s56 offen sc1
    v_exp_f32 v182, v182
    v_exp_f32 v183, v183
    v_exp_f32 v184, v184
    v_exp_f32 v185, v185
    v_smfmac_f32_32x32x32_bf16 v[40:55], v[148:151], v[176:183], v219
    v_exp_f32 v186, v186
    v_exp_f32 v187, v187
    v_exp_f32 v188, v188
    v_mfma_f32_32x32x16_bf16 v[168:183], v[136:139], v[24:27], 0
    s_add_u32 s56, s56, 71680
    v_exp_f32 v189, v189
    v_exp_f32 v190, v190
    v_exp_f32 v191, v191
    v_mfma_f32_32x32x16_bf16 v[168:183], v[140:143], v[28:31], v[168:183]
    v_exp_f32 v192, v192
    v_exp_f32 v193, v193
    v_exp_f32 v194, v194
    v_exp_f32 v195, v195
    v_exp_f32 v196, v196
    v_exp_f32 v197, v197
    v_smfmac_f32_32x32x32_bf16 v[56:71], v[144:147], v[184:191], v219
    v_exp_f32 v198, v198
    v_exp_f32 v199, v199
    v_exp_f32 v168, v168
    v_exp_f32 v169, v169
    v_smfmac_f32_32x32x32_bf16 v[56:71], v[148:151], v[192:199], v219
    v_exp_f32 v170, v170
    v_exp_f32 v171, v171
    v_exp_f32 v172, v172
    v_mfma_f32_32x32x16_bf16 v[184:199], v[136:139], v[32:35], 0
    v_exp_f32 v173, v173
    v_exp_f32 v174, v174
    v_exp_f32 v175, v175
    v_mfma_f32_32x32x16_bf16 v[184:199], v[140:143], v[36:39], v[184:199]
    v_exp_f32 v176, v176
    v_exp_f32 v177, v177
    v_exp_f32 v178, v178
    v_exp_f32 v179, v179
    v_exp_f32 v180, v180
    v_exp_f32 v181, v181
    v_smfmac_f32_32x32x32_bf16 v[72:87], v[144:147], v[168:175], v219
    s_waitcnt vmcnt(10)
    v_exp_f32 v182, v182
    v_exp_f32 v183, v183
    v_exp_f32 v184, v184
    v_exp_f32 v185, v185
    v_smfmac_f32_32x32x32_bf16 v[72:87], v[148:151], v[176:183], v219
    buffer_load_dwordx4 v[136:139], v228, s[16:19], s56 offen sc1
    v_exp_f32 v186, v186
    v_exp_f32 v187, v187
    v_exp_f32 v188, v188
    v_mfma_f32_32x32x16_bf16 v[168:183], v[152:155], v[8:11], 0
    v_exp_f32 v189, v189
    v_exp_f32 v190, v190
    v_exp_f32 v191, v191
    v_mfma_f32_32x32x16_bf16 v[168:183], v[156:159], v[12:15], v[168:183]
    v_exp_f32 v192, v192
    v_exp_f32 v193, v193
    v_exp_f32 v194, v194
    v_exp_f32 v195, v195
    v_exp_f32 v196, v196
    v_exp_f32 v197, v197
    v_smfmac_f32_32x32x32_bf16 v[88:103], v[144:147], v[184:191], v219
    buffer_load_dwordx4 v[140:143], v229, s[16:19], s56 offen sc1
    s_waitcnt vmcnt(10)
    v_exp_f32 v198, v198
    v_exp_f32 v199, v199
    v_exp_f32 v168, v168
    v_exp_f32 v169, v169
    v_smfmac_f32_32x32x32_bf16 v[88:103], v[148:151], v[192:199], v219
    buffer_load_dwordx4 v[144:147], v230, s[16:19], s56 offen sc1
    v_exp_f32 v170, v170
    v_exp_f32 v171, v171
    v_exp_f32 v172, v172
    v_mfma_f32_32x32x16_bf16 v[184:199], v[152:155], v[16:19], 0
    v_exp_f32 v173, v173
    v_exp_f32 v174, v174
    v_exp_f32 v175, v175
    v_mfma_f32_32x32x16_bf16 v[184:199], v[156:159], v[20:23], v[184:199]
    v_exp_f32 v176, v176
    v_exp_f32 v177, v177
    v_exp_f32 v178, v178
    v_exp_f32 v179, v179
    v_exp_f32 v180, v180
    v_exp_f32 v181, v181
    v_smfmac_f32_32x32x32_bf16 v[40:55], v[160:163], v[168:175], v219
    buffer_load_dwordx4 v[148:151], v231, s[16:19], s56 offen sc1
    v_exp_f32 v182, v182
    v_exp_f32 v183, v183
    v_exp_f32 v184, v184
    v_exp_f32 v185, v185
    v_smfmac_f32_32x32x32_bf16 v[40:55], v[164:167], v[176:183], v219
    v_exp_f32 v186, v186
    v_exp_f32 v187, v187
    v_exp_f32 v188, v188
    v_mfma_f32_32x32x16_bf16 v[168:183], v[152:155], v[24:27], 0
    s_add_u32 s56, s56, 71680
    v_exp_f32 v189, v189
    v_exp_f32 v190, v190
    v_exp_f32 v191, v191
    v_mfma_f32_32x32x16_bf16 v[168:183], v[156:159], v[28:31], v[168:183]
    v_exp_f32 v192, v192
    v_exp_f32 v193, v193
    v_exp_f32 v194, v194
    v_exp_f32 v195, v195
    v_exp_f32 v196, v196
    v_exp_f32 v197, v197
    v_smfmac_f32_32x32x32_bf16 v[56:71], v[160:163], v[184:191], v219
    v_exp_f32 v198, v198
    v_exp_f32 v199, v199
    v_exp_f32 v168, v168
    v_exp_f32 v169, v169
    v_smfmac_f32_32x32x32_bf16 v[56:71], v[164:167], v[192:199], v219
    v_exp_f32 v170, v170
    v_exp_f32 v171, v171
    v_exp_f32 v172, v172
    v_mfma_f32_32x32x16_bf16 v[184:199], v[152:155], v[32:35], 0
    v_exp_f32 v173, v173
    v_exp_f32 v174, v174
    v_exp_f32 v175, v175
    v_mfma_f32_32x32x16_bf16 v[184:199], v[156:159], v[36:39], v[184:199]
    v_exp_f32 v176, v176
    v_exp_f32 v177, v177
    v_exp_f32 v178, v178
    v_exp_f32 v179, v179
    v_exp_f32 v180, v180
    v_exp_f32 v181, v181
    v_smfmac_f32_32x32x32_bf16 v[72:87], v[160:163], v[168:175], v219
    s_waitcnt vmcnt(10)
    v_exp_f32 v182, v182
    v_exp_f32 v183, v183
    v_exp_f32 v184, v184
    v_exp_f32 v185, v185
    v_smfmac_f32_32x32x32_bf16 v[72:87], v[164:167], v[176:183], v219
    buffer_load_dwordx4 v[152:155], v228, s[16:19], s56 offen sc1
    v_exp_f32 v186, v186
    v_exp_f32 v187, v187
    v_exp_f32 v188, v188
    v_mfma_f32_32x32x16_bf16 v[168:183], v[104:107], v[8:11], 0
    v_exp_f32 v189, v189
    v_exp_f32 v190, v190
    v_exp_f32 v191, v191
    v_mfma_f32_32x32x16_bf16 v[168:183], v[108:111], v[12:15], v[168:183]
    s_sub_u32 s57, s57, 1
    v_exp_f32 v192, v192
    v_exp_f32 v193, v193
    v_exp_f32 v194, v194
    v_exp_f32 v195, v195
    v_exp_f32 v196, v196
    v_exp_f32 v197, v197
    v_smfmac_f32_32x32x32_bf16 v[88:103], v[160:163], v[184:191], v219
    buffer_load_dwordx4 v[156:159], v229, s[16:19], s56 offen sc1
    s_waitcnt vmcnt(10)
    v_exp_f32 v198, v198
    v_exp_f32 v199, v199
    s_cbranch_scc0 L_loop
    v_exp_f32 v168, v168
    v_exp_f32 v169, v169
    v_smfmac_f32_32x32x32_bf16 v[88:103], v[164:167], v[192:199], v219
    buffer_load_dwordx4 v[160:163], v230, s[16:19], s56 offen sc1
    v_exp_f32 v170, v170
    v_exp_f32 v171, v171
    v_exp_f32 v172, v172
    v_mfma_f32_32x32x16_bf16 v[184:199], v[104:107], v[16:19], 0
    v_exp_f32 v173, v173
    v_exp_f32 v174, v174
    v_exp_f32 v175, v175
    v_mfma_f32_32x32x16_bf16 v[184:199], v[108:111], v[20:23], v[184:199]
    v_exp_f32 v176, v176
    v_exp_f32 v177, v177
    v_exp_f32 v178, v178
    v_exp_f32 v179, v179
    v_exp_f32 v180, v180
    v_exp_f32 v181, v181
    v_smfmac_f32_32x32x32_bf16 v[40:55], v[112:115], v[168:175], v219
    buffer_load_dwordx4 v[164:167], v231, s[16:19], s56 offen sc1
    v_exp_f32 v182, v182
    v_exp_f32 v183, v183
    v_exp_f32 v184, v184
    v_exp_f32 v185, v185
    v_smfmac_f32_32x32x32_bf16 v[40:55], v[116:119], v[176:183], v219
    buffer_load_dwordx2 v[248:249], v254, s[8:11], s53 offen sc1
    v_exp_f32 v186, v186
    v_exp_f32 v187, v187
    v_exp_f32 v188, v188
    v_mfma_f32_32x32x16_bf16 v[168:183], v[104:107], v[24:27], 0
    buffer_load_dwordx4 v[240:243], v253, s[12:15], s59 offen
    v_exp_f32 v189, v189
    v_exp_f32 v190, v190
    v_exp_f32 v191, v191
    v_mfma_f32_32x32x16_bf16 v[168:183], v[108:111], v[28:31], v[168:183]
    ds_add_u32 v223, v224 offset:124
    v_exp_f32 v192, v192
    v_exp_f32 v193, v193
    v_exp_f32 v194, v194
    v_exp_f32 v195, v195
    v_exp_f32 v196, v196
    v_exp_f32 v197, v197
    v_smfmac_f32_32x32x32_bf16 v[56:71], v[112:115], v[184:191], v219
    buffer_load_dwordx4 v[244:247], v253, s[12:15], s59 offen offset:32
    v_exp_f32 v198, v198
    v_exp_f32 v199, v199
    v_exp_f32 v168, v168
    v_exp_f32 v169, v169
    v_smfmac_f32_32x32x32_bf16 v[56:71], v[116:119], v[192:199], v219
    v_exp_f32 v170, v170
    v_exp_f32 v171, v171
    v_exp_f32 v172, v172
    v_mfma_f32_32x32x16_bf16 v[184:199], v[104:107], v[32:35], 0
    v_exp_f32 v173, v173
    v_exp_f32 v174, v174
    v_exp_f32 v175, v175
    v_mfma_f32_32x32x16_bf16 v[184:199], v[108:111], v[36:39], v[184:199]
    v_exp_f32 v176, v176
    v_exp_f32 v177, v177
    v_exp_f32 v178, v178
    v_exp_f32 v179, v179
    v_exp_f32 v180, v180
    v_exp_f32 v181, v181
    v_smfmac_f32_32x32x32_bf16 v[72:87], v[112:115], v[168:175], v219
    s_waitcnt vmcnt(13)
    v_exp_f32 v182, v182
    v_exp_f32 v183, v183
    v_exp_f32 v184, v184
    v_exp_f32 v185, v185
    v_smfmac_f32_32x32x32_bf16 v[72:87], v[116:119], v[176:183], v219
    v_exp_f32 v186, v186
    v_exp_f32 v187, v187
    v_exp_f32 v188, v188
    v_mfma_f32_32x32x16_bf16 v[168:183], v[120:123], v[8:11], 0
    v_exp_f32 v189, v189
    v_exp_f32 v190, v190
    v_exp_f32 v191, v191
    v_mfma_f32_32x32x16_bf16 v[168:183], v[124:127], v[12:15], v[168:183]
    v_exp_f32 v192, v192
    v_exp_f32 v193, v193
    v_exp_f32 v194, v194
    v_exp_f32 v195, v195
    v_exp_f32 v196, v196
    v_exp_f32 v197, v197
    v_smfmac_f32_32x32x32_bf16 v[88:103], v[112:115], v[184:191], v219
    s_waitcnt vmcnt(11)
    v_exp_f32 v198, v198
    v_exp_f32 v199, v199
    v_exp_f32 v168, v168
    v_exp_f32 v169, v169
    v_smfmac_f32_32x32x32_bf16 v[88:103], v[116:119], v[192:199], v219
    v_exp_f32 v170, v170
    v_exp_f32 v171, v171
    v_exp_f32 v172, v172
    v_mfma_f32_32x32x16_bf16 v[184:199], v[120:123], v[16:19], 0
    v_exp_f32 v173, v173
    v_exp_f32 v174, v174
    v_exp_f32 v175, v175
    v_mfma_f32_32x32x16_bf16 v[184:199], v[124:127], v[20:23], v[184:199]
    v_exp_f32 v176, v176
    v_exp_f32 v177, v177
    v_exp_f32 v178, v178
    v_exp_f32 v179, v179
    v_exp_f32 v180, v180
    v_exp_f32 v181, v181
    v_smfmac_f32_32x32x32_bf16 v[40:55], v[128:131], v[168:175], v219
    v_exp_f32 v182, v182
    v_exp_f32 v183, v183
    v_exp_f32 v184, v184
    v_exp_f32 v185, v185
    v_smfmac_f32_32x32x32_bf16 v[40:55], v[132:135], v[176:183], v219
    v_exp_f32 v186, v186
    v_exp_f32 v187, v187
    v_exp_f32 v188, v188
    v_mfma_f32_32x32x16_bf16 v[168:183], v[120:123], v[24:27], 0
    v_exp_f32 v189, v189
    v_exp_f32 v190, v190
    v_exp_f32 v191, v191
    v_mfma_f32_32x32x16_bf16 v[168:183], v[124:127], v[28:31], v[168:183]
    v_exp_f32 v192, v192
    v_exp_f32 v193, v193
    v_exp_f32 v194, v194
    v_exp_f32 v195, v195
    v_exp_f32 v196, v196
    v_exp_f32 v197, v197
    v_smfmac_f32_32x32x32_bf16 v[56:71], v[128:131], v[184:191], v219
    v_exp_f32 v198, v198
    v_exp_f32 v199, v199
    v_exp_f32 v168, v168
    v_exp_f32 v169, v169
    v_smfmac_f32_32x32x32_bf16 v[56:71], v[132:135], v[192:199], v219
    v_exp_f32 v170, v170
    v_exp_f32 v171, v171
    v_exp_f32 v172, v172
    v_mfma_f32_32x32x16_bf16 v[184:199], v[120:123], v[32:35], 0
    v_exp_f32 v173, v173
    v_exp_f32 v174, v174
    v_exp_f32 v175, v175
    v_mfma_f32_32x32x16_bf16 v[184:199], v[124:127], v[36:39], v[184:199]
    v_exp_f32 v176, v176
    v_exp_f32 v177, v177
    v_exp_f32 v178, v178
    v_exp_f32 v179, v179
    v_exp_f32 v180, v180
    v_exp_f32 v181, v181
    v_smfmac_f32_32x32x32_bf16 v[72:87], v[128:131], v[168:175], v219
    s_waitcnt vmcnt(9)
    v_exp_f32 v182, v182
    v_exp_f32 v183, v183
    v_exp_f32 v184, v184
    v_exp_f32 v185, v185
    v_smfmac_f32_32x32x32_bf16 v[72:87], v[132:135], v[176:183], v219
    v_exp_f32 v186, v186
    v_exp_f32 v187, v187
    v_exp_f32 v188, v188
    v_mfma_f32_32x32x16_bf16 v[168:183], v[136:139], v[8:11], 0
    v_exp_f32 v189, v189
    v_exp_f32 v190, v190
    v_exp_f32 v191, v191
    v_mfma_f32_32x32x16_bf16 v[168:183], v[140:143], v[12:15], v[168:183]
    v_exp_f32 v192, v192
    v_exp_f32 v193, v193
    v_exp_f32 v194, v194
    v_exp_f32 v195, v195
    v_exp_f32 v196, v196
    v_exp_f32 v197, v197
    v_smfmac_f32_32x32x32_bf16 v[88:103], v[128:131], v[184:191], v219
    s_waitcnt vmcnt(7)
    v_exp_f32 v198, v198
    v_exp_f32 v199, v199
    v_exp_f32 v168, v168
    v_exp_f32 v169, v169
    v_smfmac_f32_32x32x32_bf16 v[88:103], v[132:135], v[192:199], v219
    v_exp_f32 v170, v170
    v_exp_f32 v171, v171
    v_exp_f32 v172, v172
    v_mfma_f32_32x32x16_bf16 v[184:199], v[136:139], v[16:19], 0
    v_exp_f32 v173, v173
    v_exp_f32 v174, v174
    v_exp_f32 v175, v175
    v_mfma_f32_32x32x16_bf16 v[184:199], v[140:143], v[20:23], v[184:199]
    v_exp_f32 v176, v176
    v_exp_f32 v177, v177
    v_exp_f32 v178, v178
    v_exp_f32 v179, v179
    v_exp_f32 v180, v180
    v_exp_f32 v181, v181
    v_smfmac_f32_32x32x32_bf16 v[40:55], v[144:147], v[168:175], v219
    v_exp_f32 v182, v182
    v_exp_f32 v183, v183
    v_exp_f32 v184, v184
    v_exp_f32 v185, v185
    v_smfmac_f32_32x32x32_bf16 v[40:55], v[148:151], v[176:183], v219
    v_exp_f32 v186, v186
    v_exp_f32 v187, v187
    v_exp_f32 v188, v188
    v_mfma_f32_32x32x16_bf16 v[168:183], v[136:139], v[24:27], 0
    v_exp_f32 v189, v189
    v_exp_f32 v190, v190
    v_exp_f32 v191, v191
    v_mfma_f32_32x32x16_bf16 v[168:183], v[140:143], v[28:31], v[168:183]
    v_exp_f32 v192, v192
    v_exp_f32 v193, v193
    v_exp_f32 v194, v194
    v_exp_f32 v195, v195
    v_exp_f32 v196, v196
    v_exp_f32 v197, v197
    v_smfmac_f32_32x32x32_bf16 v[56:71], v[144:147], v[184:191], v219
    v_exp_f32 v198, v198
    v_exp_f32 v199, v199
    v_exp_f32 v168, v168
    v_exp_f32 v169, v169
    v_smfmac_f32_32x32x32_bf16 v[56:71], v[148:151], v[192:199], v219
    v_exp_f32 v170, v170
    v_exp_f32 v171, v171
    v_exp_f32 v172, v172
    v_mfma_f32_32x32x16_bf16 v[184:199], v[136:139], v[32:35], 0
    v_exp_f32 v173, v173
    v_exp_f32 v174, v174
    v_exp_f32 v175, v175
    v_mfma_f32_32x32x16_bf16 v[184:199], v[140:143], v[36:39], v[184:199]
    v_exp_f32 v176, v176
    v_exp_f32 v177, v177
    v_exp_f32 v178, v178
    v_exp_f32 v179, v179
    v_exp_f32 v180, v180
    v_exp_f32 v181, v181
    v_smfmac_f32_32x32x32_bf16 v[72:87], v[144:147], v[168:175], v219
    s_waitcnt vmcnt(5)
    v_exp_f32 v182, v182
    v_exp_f32 v183, v183
    v_exp_f32 v184, v184
    v_exp_f32 v185, v185
    v_smfmac_f32_32x32x32_bf16 v[72:87], v[148:151], v[176:183], v219
    v_exp_f32 v186, v186
    v_exp_f32 v187, v187
    v_exp_f32 v188, v188
    v_mfma_f32_32x32x16_bf16 v[168:183], v[152:155], v[8:11], 0
    v_exp_f32 v189, v189
    v_exp_f32 v190, v190
    v_exp_f32 v191, v191
    v_mfma_f32_32x32x16_bf16 v[168:183], v[156:159], v[12:15], v[168:183]
    v_exp_f32 v192, v192
    v_exp_f32 v193, v193
    v_exp_f32 v194, v194
    v_exp_f32 v195, v195
    v_exp_f32 v196, v196
    v_exp_f32 v197, v197
    v_smfmac_f32_32x32x32_bf16 v[88:103], v[144:147], v[184:191], v219
    s_waitcnt vmcnt(0)
    v_exp_f32 v198, v198
    v_exp_f32 v199, v199
    v_exp_f32 v168, v168
    v_exp_f32 v169, v169
    v_smfmac_f32_32x32x32_bf16 v[88:103], v[148:151], v[192:199], v219
    v_exp_f32 v170, v170
    v_exp_f32 v171, v171
    v_exp_f32 v172, v172
    v_mfma_f32_32x32x16_bf16 v[184:199], v[152:155], v[16:19], 0
    v_exp_f32 v173, v173
    v_exp_f32 v174, v174
    v_exp_f32 v175, v175
    v_mfma_f32_32x32x16_bf16 v[184:199], v[156:159], v[20:23], v[184:199]
    v_exp_f32 v176, v176
    v_exp_f32 v177, v177
    v_exp_f32 v178, v178
    v_exp_f32 v179, v179
    v_exp_f32 v180, v180
    v_exp_f32 v181, v181
    v_smfmac_f32_32x32x32_bf16 v[40:55], v[160:163], v[168:175], v219
    v_exp_f32 v182, v182
    v_exp_f32 v183, v183
    v_exp_f32 v184, v184
    v_exp_f32 v185, v185
    v_smfmac_f32_32x32x32_bf16 v[40:55], v[164:167], v[176:183], v219
    v_exp_f32 v186, v186
    v_exp_f32 v187, v187
    v_exp_f32 v188, v188
    v_mfma_f32_32x32x16_bf16 v[168:183], v[152:155], v[24:27], 0
    v_exp_f32 v189, v189
    v_exp_f32 v190, v190
    v_exp_f32 v191, v191
    v_mfma_f32_32x32x16_bf16 v[168:183], v[156:159], v[28:31], v[168:183]
    ds_write_b128 v216, v[40:43] offset:0
    v_exp_f32 v192, v192
    v_exp_f32 v193, v193
    v_exp_f32 v194, v194
    v_exp_f32 v195, v195
    v_exp_f32 v196, v196
    v_exp_f32 v197, v197
    v_smfmac_f32_32x32x32_bf16 v[56:71], v[160:163], v[184:191], v219
    ds_write_b128 v216, v[44:47] offset:1024
    v_exp_f32 v198, v198
    v_exp_f32 v199, v199
    v_exp_f32 v168, v168
    v_exp_f32 v169, v169
    v_smfmac_f32_32x32x32_bf16 v[56:71], v[164:167], v[192:199], v219
    ds_write_b128 v216, v[48:51] offset:2048
    v_exp_f32 v170, v170
    v_exp_f32 v171, v171
    v_exp_f32 v172, v172
    v_mfma_f32_32x32x16_bf16 v[184:199], v[152:155], v[32:35], 0
    ds_write_b128 v216, v[52:55] offset:3072
    v_exp_f32 v173, v173
    v_exp_f32 v174, v174
    v_exp_f32 v175, v175
    v_mfma_f32_32x32x16_bf16 v[184:199], v[156:159], v[36:39], v[184:199]
    ds_write_b128 v217, v[56:59] offset:0
    v_exp_f32 v176, v176
    v_exp_f32 v177, v177
    v_exp_f32 v178, v178
    v_exp_f32 v179, v179
    v_exp_f32 v180, v180
    v_exp_f32 v181, v181
    v_smfmac_f32_32x32x32_bf16 v[72:87], v[160:163], v[168:175], v219
    ds_write_b128 v217, v[60:63] offset:1024
    v_exp_f32 v182, v182
    v_exp_f32 v183, v183
    v_exp_f32 v184, v184
    v_exp_f32 v185, v185
    v_smfmac_f32_32x32x32_bf16 v[72:87], v[164:167], v[176:183], v219
    ds_write_b128 v217, v[64:67] offset:2048
    v_exp_f32 v186, v186
    v_exp_f32 v187, v187
    v_exp_f32 v188, v188
    ds_write_b128 v217, v[68:71] offset:3072
    v_exp_f32 v189, v189
    v_exp_f32 v190, v190
    v_exp_f32 v191, v191
    v_exp_f32 v192, v192
    v_exp_f32 v193, v193
    v_exp_f32 v194, v194
    v_exp_f32 v195, v195
    v_exp_f32 v196, v196
    v_exp_f32 v197, v197
    v_smfmac_f32_32x32x32_bf16 v[88:103], v[160:163], v[184:191], v219
    ds_write_b128 v218, v[72:75] offset:0
    v_exp_f32 v198, v198
    v_exp_f32 v199, v199
    ds_write_b128 v218, v[76:79] offset:1024
    s_nop 0
    v_smfmac_f32_32x32x32_bf16 v[88:103], v[164:167], v[192:199], v219
    ds_write_b128 v218, v[80:83] offset:2048
    ds_write_b128 v218, v[84:87] offset:3072
    s_mov_b64 exec, 1
    ds_add_u32 v223, v224 offset:24
    s_mov_b64 exec, -1
    s_mov_b32 s20, s50
    s_mov_b32 s21, s51
    s_mov_b32 s22, 0x1c0000
    s_mov_b32 s23, 0x20000
    s_lshl_b32 s28, s35, 4
    s_add_u32 s28, s28, s31
    s_lshr_b32 s56, s28, 2
    s_lshl_b32 s56, s56, 5
    s_and_b32 s26, s31, 3
    s_add_u32 s56, s56, s26
    s_lshl_b32 s56, s56, 2
    s_add_u32 s56, s56, 6946816
    s_lshl_b32 s52, s28, 11
    s_add_u32 s52, s52, 4718592
    s_mov_b32 s57, 0
    s_mov_b32 s60, 1048576
Lsp_16:
    ds_read_b32 v7, v223 offset:24
    s_sub_u32 s60, s60, 1
    s_cbranch_scc1 L_exit
    s_waitcnt lgkmcnt(0)
    v_readfirstlane_b32 s61, v7
    s_cmp_ge_u32 s61, 6
    s_cbranch_scc0 Lsp_16
    ds_read_b128 v[168:171], v2 offset:0
    ds_read_b128 v[172:175], v2 offset:1024
    ds_read_b128 v[176:179], v2 offset:2048
    ds_read_b128 v[180:183], v2 offset:3072
    ds_read_b128 v[184:187], v2 offset:4096
    ds_read_b128 v[188:191], v2 offset:5120
    ds_read_b128 v[192:195], v2 offset:6144
    ds_read_b128 v[196:199], v2 offset:7168
    ds_read_b128 v[200:203], v2 offset:8192
    ds_read_b128 v[204:207], v2 offset:9216
    ds_read_b128 v[208:211], v2 offset:10240
    ds_read_b128 v[212:215], v2 offset:11264
    s_waitcnt lgkmcnt(8)
    v_pk_add_f32 v[100:101], v[100:101], v[180:181]
    v_pk_add_f32 v[102:103], v[102:103], v[182:183]
    v_pk_add_f32 v[88:89], v[88:89], v[168:169]
    v_pk_add_f32 v[90:91], v[90:91], v[170:171]
    v_pk_add_f32 v[92:93], v[92:93], v[172:173]
    v_pk_add_f32 v[94:95], v[94:95], v[174:175]
    v_pk_add_f32 v[96:97], v[96:97], v[176:177]
    v_pk_add_f32 v[98:99], v[98:99], v[178:179]
    s_waitcnt lgkmcnt(4)
    v_pk_add_f32 v[100:101], v[100:101], v[196:197]
    v_pk_add_f32 v[102:103], v[102:103], v[198:199]
    v_pk_add_f32 v[88:89], v[88:89], v[184:185]
    v_pk_add_f32 v[90:91], v[90:91], v[186:187]
    v_pk_add_f32 v[92:93], v[92:93], v[188:189]
    v_pk_add_f32 v[94:95], v[94:95], v[190:191]
    v_pk_add_f32 v[96:97], v[96:97], v[192:193]
    v_pk_add_f32 v[98:99], v[98:99], v[194:195]
    s_waitcnt lgkmcnt(0)
    v_pk_add_f32 v[100:101], v[100:101], v[212:213]
    v_pk_add_f32 v[102:103], v[102:103], v[214:215]
    v_pk_add_f32 v[88:89], v[88:89], v[200:201]
    v_pk_add_f32 v[90:91], v[90:91], v[202:203]
    v_pk_add_f32 v[92:93], v[92:93], v[204:205]
    v_pk_add_f32 v[94:95], v[94:95], v[206:207]
    v_pk_add_f32 v[96:97], v[96:97], v[208:209]
    v_pk_add_f32 v[98:99], v[98:99], v[210:211]
L_fin:
    v_mov_b32 v5, v100
    v_mov_b32 v4, v100
    s_mov_b32 exec_lo, 0
    v_mov_b32 v100, 0
    s_mov_b32 exec_lo, -1
    v_permlane32_swap_b32 v5, v4
    v_rcp_f32 v6, v4
    s_mov_b32 s28, 0x2b800000
    s_mov_b32 s29, 0x6c800000
    v_cmp_nle_f32 s[54:55], s28, v4
    v_cmp_nge_f32 s[62:63], s29, v4
    v_pk_add_f32 v[4:5], v[88:89], v[90:91]
    v_pk_add_f32 v[4:5], v[4:5], v[92:93]
    v_pk_add_f32 v[4:5], v[4:5], v[94:95]
    v_pk_add_f32 v[4:5], v[4:5], v[96:97]
    v_pk_add_f32 v[4:5], v[4:5], v[98:99]
    v_pk_add_f32 v[4:5], v[4:5], v[100:101]
    v_pk_add_f32 v[4:5], v[4:5], v[102:103]
    v_add_f32 v4, v4, v5
    s_movk_i32 s28, 0x207
    v_cmp_class_f32 vcc, v4, s28
    s_or_b64 s[54:55], s[54:55], s[62:63]
    v_pk_mul_f32 v[88:89], v[88:89], v[6:7] op_sel_hi:[1,0]
    v_pk_mul_f32 v[90:91], v[90:91], v[6:7] op_sel_hi:[1,0]
    v_pk_mul_f32 v[92:93], v[92:93], v[6:7] op_sel_hi:[1,0]
    v_pk_mul_f32 v[94:95], v[94:95], v[6:7] op_sel_hi:[1,0]
    v_pk_mul_f32 v[96:97], v[96:97], v[6:7] op_sel_hi:[1,0]
    v_pk_mul_f32 v[98:99], v[98:99], v[6:7] op_sel_hi:[1,0]
    v_pk_mul_f32 v[100:101], v[100:101], v[6:7] op_sel_hi:[1,0]
    v_pk_mul_f32 v[102:103], v[102:103], v[6:7] op_sel_hi:[1,0]
    v_cvt_pk_bf16_f32 v8, v88, v89
    v_cvt_pk_bf16_f32 v9, v90, v91
    v_cvt_pk_bf16_f32 v10, v92, v93
    v_cvt_pk_bf16_f32 v11, v94, v95
    v_cvt_pk_bf16_f32 v12, v96, v97
    v_cvt_pk_bf16_f32 v13, v98, v99
    v_cvt_pk_bf16_f32 v14, v100, v101
    v_cvt_pk_bf16_f32 v15, v102, v103
    v_mov_b32 v6, s30
    s_or_b64 s[54:55], s[54:55], vcc
    s_cbranch_scc1 L_bad
L_good:
    buffer_store_dwordx4 v[8:11], v1, s[8:11], s52 offen sc1
    buffer_store_dwordx4 v[12:15], v1, s[8:11], s52 offen offset:1024 sc1
    s_mov_b64 exec, 1
    buffer_atomic_swap v6, v225, s[8:11], s56 offen sc1
    s_mov_b64 exec, -1
    s_lshl2_add_u32 s28, s58, s33
    s_lshl_b32 s54, s28, 13
    s_add_u32 s54, s54, 4718592
    s_add_u32 s55, s54, 4096
    s_lshl_b32 s56, s28, 7
    s_add_u32 s56, s56, 6946816
    v_lshrrev_b32 v7, 2, v1
    v_mov_b32 v36, 0
    s_mov_b64 exec, 15
    buffer_atomic_or v36, v7, s[8:11], s56 offen sc0 sc1
    s_mov_b64 exec, -1
    v_bfe_u32 v4, v3, 2, 2
    v_lshl_add_u32 v4, v227, 2, v4
    v_mul_u32_u24 v4, 224, v4
    v_bfe_u32 v5, v3, 4, 1
    v_lshl_add_u32 v4, v5, 5, v4
    v_and_b32 v5, 1, v3
    v_lshl_add_u32 v4, v5, 4, v4
    v_bfe_u32 v5, v3, 1, 1
    v_lshl_add_u32 v4, v5, 3, v4
    s_mul_i32 s28, s33, 56
    v_add_u32 v4, s28, v4
    s_add_u32 s26, s33, 0
    s_and_b32 s26, s26, 3
    s_mul_i32 s28, s26, 25088
    v_add_u32 v24, s28, v4
    s_add_u32 s26, s33, 1
    s_and_b32 s26, s26, 3
    s_mul_i32 s28, s26, 25088
    v_add_u32 v25, s28, v4
    s_mul_i32 s28, s26, 12288
    s_add_u32 s28, s28, 102400
    v_add_u32 v33, s28, v1
    s_add_u32 s26, s33, 2
    s_and_b32 s26, s26, 3
    s_mul_i32 s28, s26, 25088
    v_add_u32 v26, s28, v4
    s_mul_i32 s28, s26, 12288
    s_add_u32 s28, s28, 102400
    v_add_u32 v34, s28, v1
    s_add_u32 s26, s33, 3
    s_and_b32 s26, s26, 3
    s_mul_i32 s28, s26, 25088
    v_add_u32 v27, s28, v4
    s_mul_i32 s28, s26, 12288
    s_add_u32 s28, s28, 102400
    v_add_u32 v35, s28, v1
    v_lshlrev_b32 v30, 2, v226
    v_add_u32 v30, 163328, v30
    s_mul_i32 s28, s33, 112
    s_add_u32 s28, s28, 159744
    v_lshl_add_u32 v28, v227, 5, s28
    v_mov_b32 v29, 163648
    s_lshl_b32 s28, 0x11, s33
    v_mov_b32 v31, s28
    s_mov_b32 s60, 1048576
Lsp_18:
    ds_read_b32 v6, v29 offset:32
    s_sub_u32 s60, s60, 1
    s_cbranch_scc1 L_exit
    s_waitcnt lgkmcnt(0)
    v_readfirstlane_b32 s61, v6
    s_cmp_ge_u32 s61, 16
    s_cbranch_scc0 Lsp_18
    v_mov_b32 v37, 0
    s_mov_b64 exec, 15
    buffer_atomic_or v37, v7, s[8:11], s56 offen sc0 sc1
    s_mov_b64 exec, -1
    ds_read_b64_tr_b16 v[104:105], v24 offset:0
    ds_read_b64_tr_b16 v[106:107], v24 offset:1792
    ds_read_b64_tr_b16 v[108:109], v24 offset:3584
    ds_read_b64_tr_b16 v[110:111], v24 offset:5376
    ds_read_b64_tr_b16 v[112:113], v24 offset:6272
    ds_read_b64_tr_b16 v[114:115], v24 offset:8064
    ds_read_b64_tr_b16 v[116:117], v24 offset:9856
    ds_read_b64_tr_b16 v[118:119], v24 offset:11648
    ds_read_b64_tr_b16 v[120:121], v24 offset:12544
    ds_read_b64_tr_b16 v[122:123], v24 offset:14336
    ds_read_b64_tr_b16 v[124:125], v24 offset:16128
    ds_read_b64_tr_b16 v[126:127], v24 offset:17920
    ds_read_b64_tr_b16 v[128:129], v24 offset:18816
    ds_read_b64_tr_b16 v[130:131], v24 offset:20608
    v_mov_b32 v38, 0
    s_mov_b64 exec, 15
    buffer_atomic_or v38, v7, s[8:11], s56 offen sc0 sc1
    s_mov_b64 exec, -1
    ds_read_b64_tr_b16 v[132:133], v24 offset:22400
    ds_read_b64_tr_b16 v[134:135], v24 offset:24192
    ds_read_b64_tr_b16 v[136:137], v25 offset:0
    ds_read_b64_tr_b16 v[138:139], v25 offset:1792
    ds_read_b64_tr_b16 v[140:141], v25 offset:3584
    ds_read_b64_tr_b16 v[142:143], v25 offset:5376
    ds_read_b64_tr_b16 v[144:145], v25 offset:6272
    ds_read_b64_tr_b16 v[146:147], v25 offset:8064
    ds_read_b64_tr_b16 v[148:149], v25 offset:9856
    ds_read_b64_tr_b16 v[150:151], v25 offset:11648
    ds_read_b64_tr_b16 v[152:153], v25 offset:12544
    ds_read_b64_tr_b16 v[154:155], v25 offset:14336
    ds_read_b64_tr_b16 v[156:157], v25 offset:16128
    ds_read_b64_tr_b16 v[158:159], v25 offset:17920
    s_mov_b32 s60, 1048576
    s_mov_b64 exec, 15
L_op:
    v_mov_b32 v39, 0
    buffer_atomic_or v39, v7, s[8:11], s56 offen sc0 sc1
    s_waitcnt vmcnt(3)
    v_cmp_ne_u32 vcc, s30, v36
    s_cbranch_vccz L_of
    v_mov_b32 v36, 0
    buffer_atomic_or v36, v7, s[8:11], s56 offen sc0 sc1
    s_waitcnt vmcnt(3)
    v_cmp_ne_u32 vcc, s30, v37
    s_cbranch_vccz L_of
    v_mov_b32 v37, 0
    buffer_atomic_or v37, v7, s[8:11], s56 offen sc0 sc1
    s_waitcnt vmcnt(3)
    v_cmp_ne_u32 vcc, s30, v38
    s_cbranch_vccz L_of
    v_mov_b32 v38, 0
    buffer_atomic_or v38, v7, s[8:11], s56 offen sc0 sc1
    s_waitcnt vmcnt(3)
    v_cmp_ne_u32 vcc, s30, v39
    s_cbranch_vccz L_of
    s_sub_u32 s60, s60, 1
    s_cbranch_scc0 L_op
    s_endpgm
L_of:
    s_mov_b64 exec, -1
    buffer_load_dwordx4 v[40:43], v1, s[8:11], s54 offen offset:0 sc1
    buffer_load_dwordx4 v[44:47], v1, s[8:11], s54 offen offset:1024 sc1
    buffer_load_dwordx4 v[48:51], v1, s[8:11], s54 offen offset:2048 sc1
    buffer_load_dwordx4 v[52:55], v1, s[8:11], s54 offen offset:3072 sc1
    buffer_load_dwordx4 v[56:59], v1, s[8:11], s55 offen offset:0 sc1
    buffer_load_dwordx4 v[60:63], v1, s[8:11], s55 offen offset:1024 sc1
    buffer_load_dwordx4 v[64:67], v1, s[8:11], s55 offen offset:2048 sc1
    buffer_load_dwordx4 v[68:71], v1, s[8:11], s55 offen offset:3072 sc1
    ds_read_b64_tr_b16 v[160:161], v25 offset:18816
    ds_read_b64_tr_b16 v[162:163], v25 offset:20608
    ds_read_b64_tr_b16 v[164:165], v25 offset:22400
    ds_read_b64_tr_b16 v[166:167], v25 offset:24192
    ds_read_b64_tr_b16 v[168:169], v26 offset:0
    ds_read_b64_tr_b16 v[170:171], v26 offset:1792
    ds_read_b64_tr_b16 v[172:173], v26 offset:3584
    ds_read_b64_tr_b16 v[174:175], v26 offset:5376
    ds_read_b64_tr_b16 v[176:177], v26 offset:6272
    ds_read_b64_tr_b16 v[178:179], v26 offset:8064
    ds_read_b64_tr_b16 v[180:181], v26 offset:9856
    ds_read_b64_tr_b16 v[182:183], v26 offset:11648
    ds_read_b64_tr_b16 v[184:185], v26 offset:12544
    ds_read_b64_tr_b16 v[186:187], v26 offset:14336
    ds_read_b64_tr_b16 v[188:189], v26 offset:16128
    ds_read_b64_tr_b16 v[190:191], v26 offset:17920
    ds_read_b64_tr_b16 v[192:193], v26 offset:18816
    ds_read_b64_tr_b16 v[194:195], v26 offset:20608
    ds_read_b64_tr_b16 v[196:197], v26 offset:22400
    ds_read_b64_tr_b16 v[198:199], v26 offset:24192
    ds_read_b64_tr_b16 v[200:201], v27 offset:0
    ds_read_b64_tr_b16 v[202:203], v27 offset:1792
    ds_read_b64_tr_b16 v[204:205], v27 offset:3584
    ds_read_b64_tr_b16 v[206:207], v27 offset:5376
    ds_read_b64_tr_b16 v[208:209], v27 offset:6272
    ds_read_b64_tr_b16 v[210:211], v27 offset:8064
    ds_read_b64_tr_b16 v[212:213], v27 offset:9856
    ds_read_b64_tr_b16 v[214:215], v27 offset:11648
    ds_read_b64_tr_b16 v[216:217], v27 offset:12544
    ds_read_b64_tr_b16 v[218:219], v27 offset:14336
    ds_read_b64_tr_b16 v[220:221], v27 offset:16128
    ds_read_b64_tr_b16 v[222:223], v27 offset:17920
    ds_read_b64_tr_b16 v[224:225], v27 offset:18816
    ds_read_b64_tr_b16 v[226:227], v27 offset:20608
    ds_read_b64_tr_b16 v[228:229], v27 offset:22400
    ds_read_b64_tr_b16 v[230:231], v27 offset:24192
    v_lshlrev_b32 v232, 16, v240
    v_and_b32 v233, 0xffff0000, v240
    v_lshlrev_b32 v234, 16, v241
    v_and_b32 v235, 0xffff0000, v241
    v_lshlrev_b32 v236, 16, v242
    v_and_b32 v237, 0xffff0000, v242
    v_lshlrev_b32 v238, 16, v243
    v_and_b32 v239, 0xffff0000, v243
    v_lshlrev_b32 v240, 16, v244
    v_and_b32 v241, 0xffff0000, v244
    v_lshlrev_b32 v242, 16, v245
    v_and_b32 v243, 0xffff0000, v245
    v_lshlrev_b32 v244, 16, v246
    v_and_b32 v245, 0xffff0000, v246
    v_lshlrev_b32 v246, 16, v247
    v_and_b32 v247, 0xffff0000, v247
    v_cmp_ne_u32 vcc, s30, v249
    s_cbranch_vccnz L_gate
L_gate_ok:
    v_sub_f32 v24, 1.0, v248
    v_cvt_pk_bf16_f32 v24, v24, v24
    v_lshlrev_b32 v24, 16, v24
    ds_read_b32 v6, v29 offset:28
    s_mov_b32 s57, 0
    s_waitcnt lgkmcnt(0)
    v_readfirstlane_b32 s61, v6
    s_bitcmp1_b32 s61, 10
    s_cbranch_scc1 L_blkU
    s_mov_b32 s57, 1
L_next0:
    v_mov_b32 v4, 0
    s_waitcnt vmcnt(7)
    ds_write_b128 v2, v[40:43] offset:0
    v_mfma_f32_32x32x16_bf16 v[8:23], v[104:107], v[40:43], 0
    v_max3_u32 v4, v4, v40, v41
    v_max3_u32 v4, v4, v42, v43
    s_waitcnt vmcnt(6)
    ds_write_b128 v2, v[44:47] offset:1024
    v_mfma_f32_32x32x16_bf16 v[8:23], v[108:111], v[44:47], v[8:23]
    v_max3_u32 v4, v4, v44, v45
    v_max3_u32 v4, v4, v46, v47
    s_waitcnt vmcnt(5)
    ds_write_b128 v2, v[48:51] offset:2048
    v_mfma_f32_32x32x16_bf16 v[8:23], v[112:115], v[48:51], v[8:23]
    v_max3_u32 v4, v4, v48, v49
    v_max3_u32 v4, v4, v50, v51
    s_waitcnt vmcnt(4)
    ds_write_b128 v2, v[52:55] offset:3072
    v_mfma_f32_32x32x16_bf16 v[8:23], v[116:119], v[52:55], v[8:23]
    v_max3_u32 v4, v4, v52, v53
    v_max3_u32 v4, v4, v54, v55
    s_waitcnt vmcnt(3)
    ds_write_b128 v2, v[56:59] offset:4096
    v_mfma_f32_32x32x16_bf16 v[8:23], v[120:123], v[56:59], v[8:23]
    v_max3_u32 v4, v4, v56, v57
    v_max3_u32 v4, v4, v58, v59
    s_waitcnt vmcnt(2)
    ds_write_b128 v2, v[60:63] offset:5120
    v_mfma_f32_32x32x16_bf16 v[8:23], v[124:127], v[60:63], v[8:23]
    v_max3_u32 v4, v4, v60, v61
    v_max3_u32 v4, v4, v62, v63
    s_waitcnt vmcnt(1)
    ds_write_b128 v2, v[64:67] offset:6144
    v_max3_u32 v4, v4, v64, v65
    v_max3_u32 v4, v4, v66, v67
    s_waitcnt vmcnt(0)
    ds_write_b128 v2, v[68:71] offset:7168
    v_max3_u32 v4, v4, v68, v69
    v_max3_u32 v4, v4, v70, v71
    v_cmp_eq_u32 vcc, -1, v4
    s_cbranch_vccnz L_again
    s_mov_b64 exec, 1
    ds_add_u32 v29, v31 offset:28
    s_mov_b64 exec, -1
    s_mov_b32 s27, s33
    ds_read_b32 v6, v29 offset:28
    s_add_u32 s27, s27, 1
    v_mfma_f32_32x32x16_bf16 v[8:23], v[128:131], v[64:67], v[8:23]
    v_mfma_f32_32x32x16_bf16 v[8:23], v[132:135], v[68:71], v[8:23]
    s_waitcnt lgkmcnt(0)
    v_readfirstlane_b32 s61, v6
    s_bitcmp1_b32 s61, s27
    s_cbranch_scc0 L_late0
    ds_read_b128 v[72:75], v33 offset:0
    ds_read_b128 v[76:79], v33 offset:1024
    ds_read_b128 v[80:83], v33 offset:2048
    ds_read_b128 v[84:87], v33 offset:3072
    ds_read_b128 v[88:91], v33 offset:4096
    ds_read_b128 v[92:95], v33 offset:5120
    ds_read_b128 v[96:99], v33 offset:6144
    ds_read_b128 v[100:103], v33 offset:7168
L_back0:
    ds_read_b32 v6, v29 offset:28
    s_add_u32 s27, s27, 1
    s_waitcnt lgkmcnt(0)
    v_mfma_f32_32x32x16_bf16 v[8:23], v[136:139], v[72:75], v[8:23]
    v_mfma_f32_32x32x16_bf16 v[8:23], v[140:143], v[76:79], v[8:23]
    v_readfirstlane_b32 s61, v6
    s_bitcmp1_b32 s61, s27
    s_cbranch_scc0 L_late1
    ds_read_b128 v[40:43], v34 offset:0
    ds_read_b128 v[44:47], v34 offset:1024
    ds_read_b128 v[48:51], v34 offset:2048
    ds_read_b128 v[52:55], v34 offset:3072
    ds_read_b128 v[56:59], v34 offset:4096
    ds_read_b128 v[60:63], v34 offset:5120
    ds_read_b128 v[64:67], v34 offset:6144
    ds_read_b128 v[68:71], v34 offset:7168
    v_mfma_f32_32x32x16_bf16 v[8:23], v[144:147], v[80:83], v[8:23]
    v_mfma_f32_32x32x16_bf16 v[8:23], v[148:151], v[84:87], v[8:23]
    v_mfma_f32_32x32x16_bf16 v[8:23], v[152:155], v[88:91], v[8:23]
    v_mfma_f32_32x32x16_bf16 v[8:23], v[156:159], v[92:95], v[8:23]
    v_mfma_f32_32x32x16_bf16 v[8:23], v[160:163], v[96:99], v[8:23]
    v_mfma_f32_32x32x16_bf16 v[8:23], v[164:167], v[100:103], v[8:23]
L_back1:
    ds_read_b32 v6, v29 offset:28
    s_add_u32 s27, s27, 1
    s_waitcnt lgkmcnt(0)
    v_mfma_f32_32x32x16_bf16 v[8:23], v[168:171], v[40:43], v[8:23]
    v_mfma_f32_32x32x16_bf16 v[8:23], v[172:175], v[44:47], v[8:23]
    v_readfirstlane_b32 s61, v6
    s_bitcmp1_b32 s61, s27
    s_cbranch_scc0 L_late2
    ds_read_b128 v[72:75], v35 offset:0
    ds_read_b128 v[76:79], v35 offset:1024
    ds_read_b128 v[80:83], v35 offset:2048
    ds_read_b128 v[84:87], v35 offset:3072
    ds_read_b128 v[88:91], v35 offset:4096
    ds_read_b128 v[92:95], v35 offset:5120
    ds_read_b128 v[96:99], v35 offset:6144
    ds_read_b128 v[100:103], v35 offset:7168
    v_mfma_f32_32x32x16_bf16 v[8:23], v[176:179], v[48:51], v[8:23]
    v_mfma_f32_32x32x16_bf16 v[8:23], v[180:183], v[52:55], v[8:23]
    v_mfma_f32_32x32x16_bf16 v[8:23], v[184:187], v[56:59], v[8:23]
    v_mfma_f32_32x32x16_bf16 v[8:23], v[188:191], v[60:63], v[8:23]
    v_mfma_f32_32x32x16_bf16 v[8:23], v[192:195], v[64:67], v[8:23]
    v_mfma_f32_32x32x16_bf16 v[8:23], v[196:199], v[68:71], v[8:23]
L_back2:
    s_waitcnt lgkmcnt(0)
    v_mfma_f32_32x32x16_bf16 v[8:23], v[200:203], v[72:75], v[8:23]
    v_mfma_f32_32x32x16_bf16 v[8:23], v[204:207], v[76:79], v[8:23]
    v_mfma_f32_32x32x16_bf16 v[8:23], v[208:211], v[80:83], v[8:23]
    v_mfma_f32_32x32x16_bf16 v[8:23], v[212:215], v[84:87], v[8:23]
    v_mfma_f32_32x32x16_bf16 v[8:23], v[216:219], v[88:91], v[8:23]
    v_mfma_f32_32x32x16_bf16 v[8:23], v[220:223], v[92:95], v[8:23]
    v_mfma_f32_32x32x16_bf16 v[8:23], v[224:227], v[96:99], v[8:23]
    v_mfma_f32_32x32x16_bf16 v[8:23], v[228:231], v[100:103], v[8:23]
L_back3:
    s_cmp_lg_u32 s57, 0
    s_cbranch_scc1 L_lateU
L_next1:
    s_nop 9
    v_pk_fma_f32 v[232:233], v[8:9], v[248:249], v[232:233] op_sel_hi:[1,0,1]
    v_pk_fma_f32 v[234:235], v[10:11], v[248:249], v[234:235] op_sel_hi:[1,0,1]
    v_pk_fma_f32 v[236:237], v[12:13], v[248:249], v[236:237] op_sel_hi:[1,0,1]
    v_pk_fma_f32 v[238:239], v[14:15], v[248:249], v[238:239] op_sel_hi:[1,0,1]
    v_cvt_pk_bf16_f32 v40, v232, v233
    v_cvt_pk_bf16_f32 v41, v234, v235
    v_cvt_pk_bf16_f32 v42, v236, v237
    v_cvt_pk_bf16_f32 v43, v238, v239
    buffer_store_dwordx4 v[40:43], v253, s[20:23], s59 offen
    v_pk_fma_f32 v[240:241], v[16:17], v[248:249], v[240:241] op_sel_hi:[1,0,1]
    v_pk_fma_f32 v[242:243], v[18:19], v[248:249], v[242:243] op_sel_hi:[1,0,1]
    v_pk_fma_f32 v[244:245], v[20:21], v[248:249], v[244:245] op_sel_hi:[1,0,1]
    v_pk_fma_f32 v[246:247], v[22:23], v[248:249], v[246:247] op_sel_hi:[1,0,1]
    v_cvt_pk_bf16_f32 v44, v240, v241
    v_cvt_pk_bf16_f32 v45, v242, v243
    v_cvt_pk_bf16_f32 v46, v244, v245
    v_cvt_pk_bf16_f32 v47, v246, v247
    s_mov_b32 exec_hi, 0
    buffer_store_dwordx4 v[44:47], v253, s[20:23], s59 offen offset:32
    s_mov_b64 exec, 0xffffffff
    s_not_b64 exec, exec
    buffer_store_dwordx2 v[44:45], v253, s[20:23], s59 offen offset:32
    s_endpgm
L_late0:
Lnd_20:
    ds_read_b32 v6, v29 offset:28
    s_sub_u32 s60, s60, 1
    s_cbranch_scc1 L_exit
    s_waitcnt lgkmcnt(0)
    v_readfirstlane_b32 s61, v6
    s_bitcmp1_b32 s61, s27
    s_cbranch_scc0 Lnd_20
    ds_read_b128 v[72:75], v33 offset:0
    ds_read_b128 v[76:79], v33 offset:1024
    ds_read_b128 v[80:83], v33 offset:2048
    ds_read_b128 v[84:87], v33 offset:3072
    ds_read_b128 v[88:91], v33 offset:4096
    ds_read_b128 v[92:95], v33 offset:5120
    ds_read_b128 v[96:99], v33 offset:6144
    ds_read_b128 v[100:103], v33 offset:7168
    s_branch L_back0
L_late1:
    v_mfma_f32_32x32x16_bf16 v[8:23], v[144:147], v[80:83], v[8:23]
    v_mfma_f32_32x32x16_bf16 v[8:23], v[148:151], v[84:87], v[8:23]
    v_mfma_f32_32x32x16_bf16 v[8:23], v[152:155], v[88:91], v[8:23]
    v_mfma_f32_32x32x16_bf16 v[8:23], v[156:159], v[92:95], v[8:23]
    v_mfma_f32_32x32x16_bf16 v[8:23], v[160:163], v[96:99], v[8:23]
    v_mfma_f32_32x32x16_bf16 v[8:23], v[164:167], v[100:103], v[8:23]
Lnd_21:
    ds_read_b32 v6, v29 offset:28
    s_sub_u32 s60, s60, 1
    s_cbranch_scc1 L_exit
    s_waitcnt lgkmcnt(0)
    v_readfirstlane_b32 s61, v6
    s_bitcmp1_b32 s61, s27
    s_cbranch_scc0 Lnd_21
    ds_read_b128 v[40:43], v34 offset:0
    ds_read_b128 v[44:47], v34 offset:1024
    ds_read_b128 v[48:51], v34 offset:2048
    ds_read_b128 v[52:55], v34 offset:3072
    ds_read_b128 v[56:59], v34 offset:4096
    ds_read_b128 v[60:63], v34 offset:5120
    ds_read_b128 v[64:67], v34 offset:6144
    ds_read_b128 v[68:71], v34 offset:7168
    s_branch L_back1
L_late2:
    v_mfma_f32_32x32x16_bf16 v[8:23], v[176:179], v[48:51], v[8:23]
    v_mfma_f32_32x32x16_bf16 v[8:23], v[180:183], v[52:55], v[8:23]
    v_mfma_f32_32x32x16_bf16 v[8:23], v[184:187], v[56:59], v[8:23]
    v_mfma_f32_32x32x16_bf16 v[8:23], v[188:191], v[60:63], v[8:23]
    v_mfma_f32_32x32x16_bf16 v[8:23], v[192:195], v[64:67], v[8:23]
    v_mfma_f32_32x32x16_bf16 v[8:23], v[196:199], v[68:71], v[8:23]
Lnd_22:
    ds_read_b32 v6, v29 offset:28
    s_sub_u32 s60, s60, 1
    s_cbranch_scc1 L_exit
    s_waitcnt lgkmcnt(0)
    v_readfirstlane_b32 s61, v6
    s_bitcmp1_b32 s61, s27
    s_cbranch_scc0 Lnd_22
    ds_read_b128 v[72:75], v35 offset:0
    ds_read_b128 v[76:79], v35 offset:1024
    ds_read_b128 v[80:83], v35 offset:2048
    ds_read_b128 v[84:87], v35 offset:3072
    ds_read_b128 v[88:91], v35 offset:4096
    ds_read_b128 v[92:95], v35 offset:5120
    ds_read_b128 v[96:99], v35 offset:6144
    ds_read_b128 v[100:103], v35 offset:7168
    s_branch L_back2
L_again:
    s_sub_u32 s60, s60, 1
    s_cbranch_scc1 L_exit
    s_waitcnt lgkmcnt(0)
    buffer_load_dwordx4 v[40:43], v1, s[8:11], s54 offen offset:0 sc1
    buffer_load_dwordx4 v[44:47], v1, s[8:11], s54 offen offset:1024 sc1
    buffer_load_dwordx4 v[48:51], v1, s[8:11], s54 offen offset:2048 sc1
    buffer_load_dwordx4 v[52:55], v1, s[8:11], s54 offen offset:3072 sc1
    buffer_load_dwordx4 v[56:59], v1, s[8:11], s55 offen offset:0 sc1
    buffer_load_dwordx4 v[60:63], v1, s[8:11], s55 offen offset:1024 sc1
    buffer_load_dwordx4 v[64:67], v1, s[8:11], s55 offen offset:2048 sc1
    buffer_load_dwordx4 v[68:71], v1, s[8:11], s55 offen offset:3072 sc1
    s_branch L_next0
L_lateU:
Lnd_23:
    ds_read_b32 v6, v29 offset:28
    s_sub_u32 s60, s60, 1
    s_cbranch_scc1 L_exit
    s_waitcnt lgkmcnt(0)
    v_readfirstlane_b32 s61, v6
    s_bitcmp1_b32 s61, 10
    s_cbranch_scc0 Lnd_23
L_blkU:
    ds_read_b32 v6, v30
    s_waitcnt lgkmcnt(0)
    v_cmp_le_i32 vcc, 0, v6
    s_cbranch_vccz L_noupd
    s_mov_b64 exec, vcc
    v_mul_u32_u24 v6, 448, v6
    v_add_u32 v28, v28, v6
    ds_read_b128 v[72:75], v28 offset:0
    ds_read_b128 v[76:79], v28 offset:16
    ds_read_b128 v[80:83], v28 offset:64
    ds_read_b128 v[84:87], v28 offset:80
    s_waitcnt lgkmcnt(0)
    v_pk_add_f32 v[232:233], v[232:233], v[72:73]
    v_cvt_pk_bf16_f32 v232, v232, v233
    v_and_b32 v233, 0xffff0000, v232
    v_lshlrev_b32 v232, 16, v232
    v_pk_add_f32 v[234:235], v[234:235], v[74:75]
    v_cvt_pk_bf16_f32 v234, v234, v235
    v_and_b32 v235, 0xffff0000, v234
    v_lshlrev_b32 v234, 16, v234
    v_pk_add_f32 v[236:237], v[236:237], v[76:77]
    v_cvt_pk_bf16_f32 v236, v236, v237
    v_and_b32 v237, 0xffff0000, v236
    v_lshlrev_b32 v236, 16, v236
    v_pk_add_f32 v[238:239], v[238:239], v[78:79]
    v_cvt_pk_bf16_f32 v238, v238, v239
    v_and_b32 v239, 0xffff0000, v238
    v_lshlrev_b32 v238, 16, v238
    v_pk_add_f32 v[240:241], v[240:241], v[80:81]
    v_cvt_pk_bf16_f32 v240, v240, v241
    v_and_b32 v241, 0xffff0000, v240
    v_lshlrev_b32 v240, 16, v240
    v_pk_add_f32 v[242:243], v[242:243], v[82:83]
    v_cvt_pk_bf16_f32 v242, v242, v243
    v_and_b32 v243, 0xffff0000, v242
    v_lshlrev_b32 v242, 16, v242
    v_pk_add_f32 v[244:245], v[244:245], v[84:85]
    v_cvt_pk_bf16_f32 v244, v244, v245
    v_and_b32 v245, 0xffff0000, v244
    v_lshlrev_b32 v244, 16, v244
    v_pk_add_f32 v[246:247], v[246:247], v[86:87]
    v_cvt_pk_bf16_f32 v246, v246, v247
    v_and_b32 v247, 0xffff0000, v246
    v_lshlrev_b32 v246, 16, v246
    s_mov_b64 exec, -1
L_noupd:
    v_pk_mul_f32 v[232:233], v[232:233], v[24:25] op_sel_hi:[1,0]
    v_pk_mul_f32 v[234:235], v[234:235], v[24:25] op_sel_hi:[1,0]
    v_pk_mul_f32 v[236:237], v[236:237], v[24:25] op_sel_hi:[1,0]
    v_pk_mul_f32 v[238:239], v[238:239], v[24:25] op_sel_hi:[1,0]
    v_pk_mul_f32 v[240:241], v[240:241], v[24:25] op_sel_hi:[1,0]
    v_pk_mul_f32 v[242:243], v[242:243], v[24:25] op_sel_hi:[1,0]
    v_pk_mul_f32 v[244:245], v[244:245], v[24:25] op_sel_hi:[1,0]
    v_pk_mul_f32 v[246:247], v[246:247], v[24:25] op_sel_hi:[1,0]
    s_cmp_lg_u32 s57, 0
    s_cbranch_scc1 L_next1
    s_branch L_next0
L_bad:
    s_cmp_eq_u32 s57, 0
    s_cbranch_scc1 L_slow
    v_min_u32 v8, -2, v8
    v_min_u32 v9, -2, v9
    v_min_u32 v10, -2, v10
    v_min_u32 v11, -2, v11
    v_min_u32 v12, -2, v12
    v_min_u32 v13, -2, v13
    v_min_u32 v14, -2, v14
    v_min_u32 v15, -2, v15
    s_branch L_good
L_nextwait:
    s_mov_b32 s60, 1048576
Lsp_24:
    ds_read_b32 v7, v251 offset:68
    s_sub_u32 s60, s60, 1
    s_cbranch_scc1 L_exit
    s_waitcnt lgkmcnt(0)
    v_readfirstlane_b32 s61, v7
    s_cmp_ge_u32 s61, 1
    s_cbranch_scc0 Lsp_24
    s_sub_u32 s56, s61, 1
    s_branch L_nextok
L_gate:
    s_mov_b32 s26, 6832128
    s_mov_b32 s60, 1048576
L_gate1:
    buffer_load_dwordx2 v[248:249], v254, s[8:11], s26 offen sc1
    s_waitcnt vmcnt(0)
    v_cmp_ne_u32 vcc, s30, v249
    s_cbranch_vccz L_gate_ok
    s_sub_u32 s60, s60, 1
    s_cbranch_scc0 L_gate1
    s_endpgm
L_slow:
    s_mov_b32 s57, 1
    s_mov_b32 s55, 4587520
    s_mov_b32 s54, 0
    s_mov_b32 exec_lo, 0
    v_mov_b32 v38, 0
    v_mov_b32 v39, 0
    s_mov_b32 exec_lo, -1
    v_mov_b32 v4, 0xff800000
L_slow1:
    buffer_load_dwordx4 v[104:107], v228, s[16:19], s54 offen sc1
    buffer_load_dwordx4 v[108:111], v229, s[16:19], s54 offen sc1
    s_waitcnt vmcnt(0)
    v_mfma_f32_32x32x16_bf16 v[168:183], v[104:107], v[32:35], 0
    v_mfma_f32_32x32x16_bf16 v[168:183], v[108:111], v[36:39], v[168:183]
    s_nop 11
    v_max3_f32 v4, v4, v168, v169
    v_max3_f32 v4, v4, v170, v171
    v_max3_f32 v4, v4, v172, v173
    v_max3_f32 v4, v4, v174, v175
    v_max3_f32 v4, v4, v176, v177
    v_max3_f32 v4, v4, v178, v179
    v_max3_f32 v4, v4, v180, v181
    v_max3_f32 v4, v4, v182, v183
    s_add_u32 s54, s54, 71680
    s_cmp_lt_u32 s54, s55
    s_cbranch_scc1 L_slow1
    v_mov_b32 v5, v4
    s_nop 1
    v_permlane32_swap_b32 v4, v5
    v_max_f32 v4, v4, v5
    v_sub_f32 v4, 0, v4
    v_cvt_pk_bf16_f32 v5, v4, v4
    v_lshlrev_b32 v5, 16, v5
    v_sub_f32 v5, v4, v5
    v_cvt_pk_bf16_f32 v6, v4, v5
    v_and_b32 v4, 0xffff0000, v6
    v_sub_f32 v5, v5, v4
    s_mov_b32 exec_lo, 0
    v_mov_b32 v38, v6
    v_cvt_pk_bf16_f32 v39, v5, 0
    s_mov_b32 exec_lo, -1
    v_mov_b32 v88, 0
    v_mov_b32 v89, 0
    v_mov_b32 v90, 0
    v_mov_b32 v91, 0
    v_mov_b32 v92, 0
    v_mov_b32 v93, 0
    v_mov_b32 v94, 0
    v_mov_b32 v95, 0
    v_mov_b32 v96, 0
    v_mov_b32 v97, 0
    v_mov_b32 v98, 0
    v_mov_b32 v99, 0
    v_mov_b32 v100, 0
    v_mov_b32 v101, 0
    v_mov_b32 v102, 0
    v_mov_b32 v103, 0
    s_mov_b32 s54, 0
L_slow2:
    buffer_load_dwordx4 v[104:107], v228, s[16:19], s54 offen sc1
    buffer_load_dwordx4 v[108:111], v229, s[16:19], s54 offen sc1
    buffer_load_dwordx4 v[112:115], v230, s[16:19], s54 offen sc1
    buffer_load_dwordx4 v[116:119], v231, s[16:19], s54 offen sc1
    s_waitcnt vmcnt(0)
    v_mfma_f32_32x32x16_bf16 v[168:183], v[104:107], v[32:35], 0
    v_mfma_f32_32x32x16_bf16 v[168:183], v[108:111], v[36:39], v[168:183]
    s_nop 11
    v_exp_f32 v168, v168
    v_exp_f32 v169, v169
    v_exp_f32 v170, v170
    v_exp_f32 v171, v171
    v_exp_f32 v172, v172
    v_exp_f32 v173, v173
    v_exp_f32 v174, v174
    v_exp_f32 v175, v175
    v_exp_f32 v176, v176
    v_exp_f32 v177, v177
    v_exp_f32 v178, v178
    v_exp_f32 v179, v179
    v_exp_f32 v180, v180
    v_exp_f32 v181, v181
    v_exp_f32 v182, v182
    v_exp_f32 v183, v183
    v_smfmac_f32_32x32x32_bf16 v[88:103], v[112:115], v[168:175], v219
    s_nop 0
    v_smfmac_f32_32x32x32_bf16 v[88:103], v[116:119], v[176:183], v219
    s_nop 7
    s_nop 7
    s_add_u32 s54, s54, 71680
    s_cmp_lt_u32 s54, s55
    s_cbranch_scc1 L_slow2
    s_branch L_fin
L_service:
    v_mov_b32 v14, 163648
    v_mov_b32 v15, 1
    v_mov_b32 v12, 0
    v_mov_b32 v9, 0
    s_mov_b32 s8, s36
    s_mov_b32 s9, s37
    s_mov_b32 s10, 0x10000000
    s_mov_b32 s11, 0x20000
    s_waitcnt lgkmcnt(0)
    s_mul_i32 s30, s30, 0x9e3779b1
    s_add_u32 s30, s30, 0x7f4a7c15
    v_mov_b32 v4, s30
    ds_write_b32 v14, v4 offset:44
    s_waitcnt vmcnt(0)
    s_mov_b64 exec, 1
    ds_add_u32 v14, v15 offset:0
    s_mov_b64 exec, -1
    v_and_b32 v32, 31, v3
    v_lshrrev_b32 v33, 5, v3
    v_lshlrev_b32 v219, 3, v1
    v_lshrrev_b32 v220, 2, v1
    v_and_b32 v4, 7, v3
    v_lshlrev_b32 v217, 3, v4
    s_lshr_b32 s58, s31, 2
    s_lshl2_add_u32 s58, s32, s58
    v_lshlrev_b32 v211, 11, v33
    v_lshl_add_u32 v211, v32, 4, v211
    v_and_b32 v4, 24, v3
    v_lshl_add_u32 v4, v33, 2, v4
    v_lshl_add_u32 v4, v217, 4, v4
    s_lshl_b32 s26, s35, 5
    s_add_u32 s26, s26, 101376
    v_add_u32 v214, s26, v4
    s_mul_i32 s66, s2, 9363
    s_lshr_b32 s66, s66, 16
    s_mul_i32 s26, s66, 7
    s_sub_u32 s67, s2, s26
    s_cmp_ge_u32 s35, 2
    s_cbranch_scc1 L_svcB
    s_lshl_b32 s27, s32, 6
    s_add_u32 s27, s27, 6815744
    s_cmp_eq_u32 s34, 14
    s_cbranch_scc1 L_rank
    s_cmp_lg_u32 s2, 223
    s_cbranch_scc1 L_svcA
    s_lshl_b32 s28, s35, 8
    s_add_u32 s28, s28, 159744
    v_add_u32 v7, s28, v220
    v_lshl_add_u32 v6, v33, 7, s28
    s_lshl_b32 s28, s35, 6
    s_add_u32 s28, s28, 160256
    v_lshl_add_u32 v10, v33, 5, s28
    s_lshl_b32 s26, s35, 9
    s_add_u32 s26, s26, 6815744
    s_mov_b32 s27, 6848512
    v_lshlrev_b32 v4, 3, v3
    v_mov_b32 v5, 2
    s_mov_b32 s60, 1048576
L_keys:
    v_mov_b32 v20, 0
    v_mov_b32 v21, 0
    buffer_atomic_or_x2 v[20:21], v4, s[8:11], s26 offen sc0 sc1
    s_sub_u32 s60, s60, 1
    s_cbranch_scc1 L_exit
    s_waitcnt vmcnt(0)
    v_cmp_ne_u32 vcc, s30, v21
    s_cbranch_vccnz L_keys
    ds_write_b32 v7, v20
    ds_read_b128 v[40:43], v6 offset:0
    ds_read_b128 v[44:47], v6 offset:16
    ds_read_b128 v[48:51], v6 offset:32
    ds_read_b128 v[52:55], v6 offset:48
    ds_read_b128 v[56:59], v6 offset:64
    ds_read_b128 v[60:63], v6 offset:80
    ds_read_b128 v[64:67], v6 offset:96
    ds_read_b128 v[68:71], v6 offset:112
    v_mov_b32 v22, 0
    v_mov_b32 v23, 0
    s_waitcnt lgkmcnt(7)
    v_sub_u32 v40, v20, v40
    v_sub_u32 v41, v20, v41
    v_sub_u32 v42, v20, v42
    v_sub_u32 v43, v20, v43
    v_alignbit_b32 v22, v22, v40, 31
    v_alignbit_b32 v23, v23, v41, 31
    v_alignbit_b32 v22, v22, v42, 31
    v_alignbit_b32 v23, v23, v43, 31
    s_waitcnt lgkmcnt(6)
    v_sub_u32 v44, v20, v44
    v_sub_u32 v45, v20, v45
    v_sub_u32 v46, v20, v46
    v_sub_u32 v47, v20, v47
    v_alignbit_b32 v22, v22, v44, 31
    v_alignbit_b32 v23, v23, v45, 31
    v_alignbit_b32 v22, v22, v46, 31
    v_alignbit_b32 v23, v23, v47, 31
    s_waitcnt lgkmcnt(5)
    v_sub_u32 v48, v20, v48
    v_sub_u32 v49, v20, v49
    v_sub_u32 v50, v20, v50
    v_sub_u32 v51, v20, v51
    v_alignbit_b32 v22, v22, v48, 31
    v_alignbit_b32 v23, v23, v49, 31
    v_alignbit_b32 v22, v22, v50, 31
    v_alignbit_b32 v23, v23, v51, 31
    s_waitcnt lgkmcnt(4)
    v_sub_u32 v52, v20, v52
    v_sub_u32 v53, v20, v53
    v_sub_u32 v54, v20, v54
    v_sub_u32 v55, v20, v55
    v_alignbit_b32 v22, v22, v52, 31
    v_alignbit_b32 v23, v23, v53, 31
    v_alignbit_b32 v22, v22, v54, 31
    v_alignbit_b32 v23, v23, v55, 31
    s_waitcnt lgkmcnt(3)
    v_sub_u32 v56, v20, v56
    v_sub_u32 v57, v20, v57
    v_sub_u32 v58, v20, v58
    v_sub_u32 v59, v20, v59
    v_alignbit_b32 v22, v22, v56, 31
    v_alignbit_b32 v23, v23, v57, 31
    v_alignbit_b32 v22, v22, v58, 31
    v_alignbit_b32 v23, v23, v59, 31
    s_waitcnt lgkmcnt(2)
    v_sub_u32 v60, v20, v60
    v_sub_u32 v61, v20, v61
    v_sub_u32 v62, v20, v62
    v_sub_u32 v63, v20, v63
    v_alignbit_b32 v22, v22, v60, 31
    v_alignbit_b32 v23, v23, v61, 31
    v_alignbit_b32 v22, v22, v62, 31
    v_alignbit_b32 v23, v23, v63, 31
    s_waitcnt lgkmcnt(1)
    v_sub_u32 v64, v20, v64
    v_sub_u32 v65, v20, v65
    v_sub_u32 v66, v20, v66
    v_sub_u32 v67, v20, v67
    v_alignbit_b32 v22, v22, v64, 31
    v_alignbit_b32 v23, v23, v65, 31
    v_alignbit_b32 v22, v22, v66, 31
    v_alignbit_b32 v23, v23, v67, 31
    s_waitcnt lgkmcnt(0)
    v_sub_u32 v68, v20, v68
    v_sub_u32 v69, v20, v69
    v_sub_u32 v70, v20, v70
    v_sub_u32 v71, v20, v71
    v_alignbit_b32 v22, v22, v68, 31
    v_alignbit_b32 v23, v23, v69, 31
    v_alignbit_b32 v22, v22, v70, 31
    v_alignbit_b32 v23, v23, v71, 31
    v_bcnt_u32_b32 v22, v22, 0
    v_bcnt_u32_b32 v22, v23, v22
    v_cmp_gt_u32 vcc, 8, v22
    v_lshl_add_u32 v22, v22, 2, v10
    s_mov_b64 exec, vcc
    ds_write_b32 v22, v20
    s_mov_b64 exec, 1
    ds_add_u32 v14, v5 offset:40
    s_mov_b64 exec, -1
L_rank:
    s_cmp_lg_u32 s35, 0
    s_cbranch_scc1 L_svcA
    v_mov_b32 v6, 160256
    v_lshl_add_u32 v7, v32, 2, v6
    v_lshl_add_u32 v6, v33, 6, v6
    v_mov_b32 v21, s30
    s_mov_b32 s60, 1048576
Lsp_26:
    ds_read_b32 v8, v14 offset:40
    s_sub_u32 s60, s60, 1
    s_cbranch_scc1 L_exit
    s_waitcnt lgkmcnt(0)
    v_readfirstlane_b32 s61, v8
    s_cmp_ge_u32 s61, 4
    s_cbranch_scc0 Lsp_26
    ds_read_b32 v20, v7
    ds_read_b128 v[40:43], v6 offset:0
    ds_read_b128 v[44:47], v6 offset:16
    ds_read_b128 v[48:51], v6 offset:32
    ds_read_b128 v[52:55], v6 offset:48
    v_mov_b32 v22, 0
    v_mov_b32 v23, 0
    s_waitcnt lgkmcnt(3)
    v_sub_u32 v40, v20, v40
    v_sub_u32 v41, v20, v41
    v_sub_u32 v42, v20, v42
    v_sub_u32 v43, v20, v43
    v_alignbit_b32 v22, v22, v40, 31
    v_alignbit_b32 v23, v23, v41, 31
    v_alignbit_b32 v22, v22, v42, 31
    v_alignbit_b32 v23, v23, v43, 31
    s_waitcnt lgkmcnt(2)
    v_sub_u32 v44, v20, v44
    v_sub_u32 v45, v20, v45
    v_sub_u32 v46, v20, v46
    v_sub_u32 v47, v20, v47
    v_alignbit_b32 v22, v22, v44, 31
    v_alignbit_b32 v23, v23, v45, 31
    v_alignbit_b32 v22, v22, v46, 31
    v_alignbit_b32 v23, v23, v47, 31
    s_waitcnt lgkmcnt(1)
    v_sub_u32 v48, v20, v48
    v_sub_u32 v49, v20, v49
    v_sub_u32 v50, v20, v50
    v_sub_u32 v51, v20, v51
    v_alignbit_b32 v22, v22, v48, 31
    v_alignbit_b32 v23, v23, v49, 31
    v_alignbit_b32 v22, v22, v50, 31
    v_alignbit_b32 v23, v23, v51, 31
    s_waitcnt lgkmcnt(0)
    v_sub_u32 v52, v20, v52
    v_sub_u32 v53, v20, v53
    v_sub_u32 v54, v20, v54
    v_sub_u32 v55, v20, v55
    v_alignbit_b32 v22, v22, v52, 31
    v_alignbit_b32 v23, v23, v53, 31
    v_alignbit_b32 v22, v22, v54, 31
    v_alignbit_b32 v23, v23, v55, 31
    v_bcnt_u32_b32 v22, v22, 0
    v_bcnt_u32_b32 v22, v23, v22
    v_mov_b32 v23, v22
    s_nop 1
    v_permlane32_swap_b32 v22, v23
    v_add_u32 v22, v22, v23
    v_cmp_gt_u32 vcc, 8, v22
    v_lshlrev_b32 v22, 3, v22
    s_mov_b32 exec_lo, vcc_lo
    s_mov_b32 exec_hi, 0
    buffer_atomic_swap_x2 v[20:21], v22, s[8:11], s27 offen sc1
    s_mov_b64 exec, -1
L_svcA:
    v_add_u32 v4, 0, v3
    v_mul_u32_u24 v5, 4682, v4
    v_lshrrev_b32 v5, 16, v5
    v_mul_u32_u24 v5, 672, v5
    v_lshl_add_u32 v200, v4, 4, v5
    v_add_u32 v4, 64, v3
    v_mul_u32_u24 v5, 4682, v4
    v_lshrrev_b32 v5, 16, v5
    v_mul_u32_u24 v5, 672, v5
    v_lshl_add_u32 v201, v4, 4, v5
    v_add_u32 v4, 128, v3
    v_mul_u32_u24 v5, 4682, v4
    v_lshrrev_b32 v5, 16, v5
    v_mul_u32_u24 v5, 672, v5
    v_lshl_add_u32 v202, v4, 4, v5
    v_add_u32 v4, 192, v3
    v_mul_u32_u24 v5, 4682, v4
    v_lshrrev_b32 v5, 16, v5
    v_mul_u32_u24 v5, 672, v5
    v_lshl_add_u32 v203, v4, 4, v5
    v_add_u32 v4, 256, v3
    v_mul_u32_u24 v5, 4682, v4
    v_lshrrev_b32 v5, 16, v5
    v_mul_u32_u24 v5, 672, v5
    v_lshl_add_u32 v204, v4, 4, v5
    v_add_u32 v4, 320, v3
    v_mul_u32_u24 v5, 4682, v4
    v_lshrrev_b32 v5, 16, v5
    v_mul_u32_u24 v5, 672, v5
    v_lshl_add_u32 v205, v4, 4, v5
    v_add_u32 v4, 384, v3
    v_mul_u32_u24 v5, 4682, v4
    v_lshrrev_b32 v5, 16, v5
    v_mul_u32_u24 v5, 672, v5
    v_lshl_add_u32 v206, v4, 4, v5
    v_mov_b32 v215, 0
    v_mov_b32 v216, 0
    v_mov_b32 v28, -1
    v_mov_b32 v29, -1
    v_mov_b32 v30, -1
    v_mov_b32 v31, -1
    s_lshl_b32 s59, s32, 6
    s_add_u32 s59, s59, s31
    s_lshl1_add_u32 s59, s59, s35
    s_lshl_b32 s59, s59, 10
    s_add_u32 s59, s59, 4718592
    s_cmp_ge_u32 s2, 196
    s_cbranch_scc1 L_nofn
    v_lshrrev_b32 v4, 3, v3
    v_and_b32 v5, 2, v4
    v_lshlrev_b32 v5, 1, v5
    v_and_b32 v6, 7, v3
    v_xor_b32 v5, v5, v6
    v_mul_u32_u24 v6, 3584, v4
    v_lshl_add_u32 v34, v5, 4, v6
    v_add_u32 v35, 27648, v34
    v_add_u32 v36, 55296, v34
    v_add_u32 v37, 82944, v34
    v_mul_u32_u24 v6, 896, v4
    v_lshl_add_u32 v240, v5, 4, v6
    v_add_u32 v241, 6144, v240
    v_add_u32 v242, 12288, v240
    v_add_u32 v243, 18432, v240
    s_lshl_b32 s54, s35, 13
    s_add_u32 s54, s54, 0
    v_and_b32 v4, 3, v3
    v_lshrrev_b32 v6, 4, v3
    v_bfe_u32 v7, v3, 2, 2
    v_lshl_add_u32 v8, v6, 3, v7
    v_lshlrev_b32 v8, 7, v8
    v_lshrrev_b32 v7, 1, v7
    v_lshl_add_u32 v8, v7, 6, v8
    v_lshl_add_u32 v8, v4, 3, v8
    v_add_u32 v38, s54, v8
    v_xor_b32 v39, 64, v38
    v_lshlrev_b32 v213, 4, v6
    v_lshlrev_b32 v212, 3, v213
    v_lshl_add_u32 v212, v217, 1, v212
    s_mov_b32 s16, s42
    s_mov_b32 s17, s43
    s_mov_b32 s18, 0x188000
    s_mov_b32 s19, 0x20000
    s_cmp_eq_u32 s35, 1
    s_cselect_b64 s[16:17], s[44:45], s[42:43]
    s_mul_i32 s52, s67, 229376
    s_lshl_b32 s28, s66, 7
    s_add_u32 s52, s52, s28
    s_movk_i32 s29, 896
    s_mov_b32 s60, 1048576
Lsp_28:
    ds_read_b32 v8, v14 offset:92
    s_waitcnt lgkmcnt(0)
    v_readfirstlane_b32 s61, v8
    s_cmp_ge_u32 s61, 256
    s_cbranch_scc1 Lsd_29
    s_sleep 4
    s_sub_u32 s60, s60, 1
    s_cbranch_scc0 Lsp_28
    s_endpgm
Lsd_29:
    s_mov_b32 m0, s54
    s_nop 0
    buffer_load_dwordx4 v34, s[16:19], s52 offen offset:0 lds
    buffer_load_dwordx4 v35, s[16:19], s52 offen offset:1024 lds
    buffer_load_dwordx4 v36, s[16:19], s52 offen offset:2048 lds
    buffer_load_dwordx4 v37, s[16:19], s52 offen offset:3072 lds
    s_add_u32 s52, s52, 114688
    s_add_u32 m0, s54, 4096
    s_mov_b32 s26, 6848512
    s_mov_b32 s60, 1048576
L_sel1:
    buffer_load_dwordx2 v[20:21], v217, s[8:11], s26 offen sc1
    s_waitcnt vmcnt(0)
    v_cmp_ne_u32 vcc, s30, v21
    s_cbranch_vccz L_sel1_ok
    s_sleep 4
    s_sub_u32 s60, s60, 1
    s_cbranch_scc0 L_sel1
    s_endpgm
L_sel1_ok:
    buffer_load_dwordx4 v34, s[16:19], s52 offen offset:0 lds
    buffer_load_dwordx4 v35, s[16:19], s52 offen offset:1024 lds
    buffer_load_dwordx4 v36, s[16:19], s52 offen offset:2048 lds
    buffer_load_dwordx4 v37, s[16:19], s52 offen offset:3072 lds
    v_not_b32 v4, v20
    v_and_b32 v4, 0x7ff, v4
    v_mad_u32_u24 v4, v4, s29, v213
    s_lshl_b32 s26, s67, 7
    s_mov_b32 exec_lo, 0x00ff00ff
    s_mov_b32 exec_hi, 0x00ff00ff
    buffer_load_dwordx4 v[40:43], v4, s[12:15], s26 offen
    buffer_load_dwordx4 v[44:47], v4, s[12:15], s26 offen offset:64
    s_mov_b64 exec, -1
    s_waitcnt vmcnt(2)
    ds_read_b64_tr_b16 v[56:57], v38 offset:0
    ds_read_b64_tr_b16 v[58:59], v38 offset:512
    ds_read_b64_tr_b16 v[60:61], v38 offset:32
    ds_read_b64_tr_b16 v[62:63], v38 offset:544
    ds_read_b64_tr_b16 v[64:65], v39 offset:0
    ds_read_b64_tr_b16 v[66:67], v39 offset:512
    ds_read_b64_tr_b16 v[68:69], v39 offset:32
    ds_read_b64_tr_b16 v[70:71], v39 offset:544
    ds_read_b64_tr_b16 v[72:73], v38 offset:4096
    ds_read_b64_tr_b16 v[74:75], v38 offset:4608
    ds_read_b64_tr_b16 v[76:77], v38 offset:4128
    ds_read_b64_tr_b16 v[78:79], v38 offset:4640
    ds_read_b64_tr_b16 v[80:81], v39 offset:4096
    ds_read_b64_tr_b16 v[82:83], v39 offset:4608
    ds_read_b64_tr_b16 v[84:85], v39 offset:4128
    ds_read_b64_tr_b16 v[86:87], v39 offset:4640
    s_mov_b64 s[16:17], s[46:47]
    s_lshl1_add_u32 s28, s66, s35
    s_mul_i32 s28, s28, 28672
    s_add_u32 s28, s28, s26
    s_lshl_b32 s29, s35, 12
    s_add_u32 m0, s29, 151552
    s_lshl1_add_u32 s26, s2, s35
    s_lshl_b32 s26, s26, 11
    s_add_u32 s26, s26, 7536640
    s_waitcnt vmcnt(0) lgkmcnt(0)
    v_mfma_f32_16x16x32_bf16 v[104:107], v[56:59], v[40:43], 0
    v_mfma_f32_16x16x32_bf16 v[108:111], v[60:63], v[40:43], 0
    v_mfma_f32_16x16x32_bf16 v[112:115], v[64:67], v[40:43], 0
    v_mfma_f32_16x16x32_bf16 v[116:119], v[68:71], v[40:43], 0
    v_mfma_f32_16x16x32_bf16 v[104:107], v[72:75], v[44:47], v[104:107]
    v_mfma_f32_16x16x32_bf16 v[108:111], v[76:79], v[44:47], v[108:111]
    v_mfma_f32_16x16x32_bf16 v[112:115], v[80:83], v[44:47], v[112:115]
    v_mfma_f32_16x16x32_bf16 v[116:119], v[84:87], v[44:47], v[116:119]
    s_mov_b32 exec_lo, 0x00ff00ff
    s_mov_b32 exec_hi, 0x00ff00ff
    s_nop 2
    buffer_store_dwordx4 v[104:107], v212, s[8:11], s26 offen offset:0 sc1
    buffer_store_dwordx4 v[108:111], v212, s[8:11], s26 offen offset:512 sc1
    buffer_store_dwordx4 v[112:115], v212, s[8:11], s26 offen offset:1024 sc1
    buffer_store_dwordx4 v[116:119], v212, s[8:11], s26 offen offset:1536 sc1
    s_mov_b64 exec, -1
    buffer_load_dwordx4 v240, s[16:19], s28 offen offset:0 lds
    buffer_load_dwordx4 v241, s[16:19], s28 offen offset:1024 lds
    buffer_load_dwordx4 v242, s[16:19], s28 offen offset:2048 lds
    buffer_load_dwordx4 v243, s[16:19], s28 offen offset:3072 lds
    s_lshl1_add_u32 s26, s67, s35
    s_lshl_b32 s26, s26, 2
    s_mul_i32 s28, s66, 896
    s_add_u32 s26, s26, s28
    s_add_u32 s26, s26, 6983680
    s_waitcnt vmcnt(4)
    v_mov_b32 v5, s30
    s_mov_b64 exec, 0x7f
    buffer_atomic_swap v5, v219, s[8:11], s26 offen sc1
    s_mov_b64 exec, -1
    s_cmp_lg_u32 s35, 0
    s_cbranch_scc1 L_st2w
    s_lshl_b32 s26, s2, 7
    s_add_u32 s26, s26, 6983680
    s_mov_b32 s60, 1048576
    s_mov_b64 exec, 0x3fff
Lpa_30:
    v_mov_b32 v5, 0
    buffer_atomic_or v5, v220, s[8:11], s26 offen sc0 sc1
    s_waitcnt vmcnt(0)
    v_cmp_ne_u32 vcc, s30, v5
    s_cbranch_vccz Lpad_31
    s_sleep 2
    s_sub_u32 s60, s60, 1
    s_cbranch_scc0 Lpa_30
    s_endpgm
Lpad_31:
    s_mov_b64 exec, -1
    s_mov_b64 exec, 1
    ds_add_u32 v14, v15 offset:12
    s_mov_b64 exec, -1
L_st2w:
    s_mov_b32 s60, 1048576
Lsp_32:
    ds_read_b32 v8, v14 offset:12
    s_waitcnt lgkmcnt(0)
    v_readfirstlane_b32 s61, v8
    s_cmp_ge_u32 s61, 1
    s_cbranch_scc1 Lsd_33
    s_sleep 3
    s_sub_u32 s60, s60, 1
    s_cbranch_scc0 Lsp_32
    s_endpgm
Lsd_33:
    s_mul_i32 s26, s66, 28672
    s_lshl_b32 s28, s35, 9
    s_add_u32 s26, s26, s28
    s_add_u32 s26, s26, 7536640
    buffer_load_dwordx4 v[40:43], v211, s[8:11], s26 offen sc1
    s_add_u32 s26, s26, 4096
    buffer_load_dwordx4 v[44:47], v211, s[8:11], s26 offen sc1
    s_add_u32 s26, s26, 4096
    buffer_load_dwordx4 v[48:51], v211, s[8:11], s26 offen sc1
    s_add_u32 s26, s26, 4096
    buffer_load_dwordx4 v[52:55], v211, s[8:11], s26 offen sc1
    s_add_u32 s26, s26, 4096
    buffer_load_dwordx4 v[56:59], v211, s[8:11], s26 offen sc1
    s_add_u32 s26, s26, 4096
    buffer_load_dwordx4 v[60:63], v211, s[8:11], s26 offen sc1
    s_add_u32 s26, s26, 4096
    buffer_load_dwordx4 v[64:67], v211, s[8:11], s26 offen sc1
    s_mov_b32 s28, 0xbfb8aa3b
    s_waitcnt vmcnt(0)
    v_pk_add_f32 v[40:41], v[40:41], v[44:45]
    v_pk_add_f32 v[42:43], v[42:43], v[46:47]
    v_pk_add_f32 v[40:41], v[40:41], v[48:49]
    v_pk_add_f32 v[42:43], v[42:43], v[50:51]
    v_pk_add_f32 v[40:41], v[40:41], v[52:53]
    v_pk_add_f32 v[42:43], v[42:43], v[54:55]
    v_pk_add_f32 v[40:41], v[40:41], v[56:57]
    v_pk_add_f32 v[42:43], v[42:43], v[58:59]
    v_pk_add_f32 v[40:41], v[40:41], v[60:61]
    v_pk_add_f32 v[42:43], v[42:43], v[62:63]
    v_pk_add_f32 v[40:41], v[40:41], v[64:65]
    v_pk_add_f32 v[42:43], v[42:43], v[66:67]
    s_nop 1
    v_permlane32_swap_b32 v40, v42
    v_permlane32_swap_b32 v41, v43
    v_mul_f32 v22, s28, v40
    v_mul_f32 v23, s28, v41
    v_exp_f32 v22, v22
    v_exp_f32 v23, v23
    v_add_f32 v22, 1.0, v22
    v_add_f32 v23, 1.0, v23
    v_rcp_f32 v22, v22
    v_rcp_f32 v23, v23
    s_nop 0
    v_pk_mul_f32 v[22:23], v[22:23], v[40:41]
    v_pk_mul_f32 v[22:23], v[22:23], v[42:43]
    v_cvt_pk_bf16_f32 v22, v22, v23
    ds_write_b32 v214, v22
    s_mov_b64 exec, 1
    ds_add_u32 v14, v15 offset:16
    s_mov_b64 exec, -1
    s_cmp_ge_u32 s35, 2
    s_cbranch_scc1 L_st3
    s_branch L_clr
L_nofn:
    s_mov_b32 s60, 1048576
Lsp_34:
    ds_read_b32 v8, v14 offset:92
    s_waitcnt lgkmcnt(0)
    v_readfirstlane_b32 s61, v8
    s_cmp_ge_u32 s61, 512
    s_cbranch_scc1 Lsd_35
    s_sleep 8
    s_sub_u32 s60, s60, 1
    s_cbranch_scc0 Lsp_34
    s_endpgm
Lsd_35:
    s_mov_b32 s16, s38
    s_mov_b32 s17, s39
    s_mov_b32 s18, 0x62000
    s_mov_b32 s19, 0x20000
    s_sub_u32 s26, s2, 196
    s_lshl1_add_u32 s26, s26, s35
    s_mul_i32 s26, s26, 3456
    s_min_u32 s26, s26, 397952
    s_mov_b64 exec, 0x7ffffff
    buffer_load_dword v6, v219, s[16:19], s26 offen
    s_mov_b64 exec, -1
    s_mov_b32 s26, 6848512
    s_mov_b32 s60, 1048576
L_sel2:
    buffer_load_dwordx2 v[20:21], v217, s[8:11], s26 offen sc1
    s_waitcnt vmcnt(0)
    v_cmp_ne_u32 vcc, s30, v21
    s_cbranch_vccz L_sel2_ok
    s_sleep 4
    s_sub_u32 s60, s60, 1
    s_cbranch_scc0 L_sel2
    s_endpgm
L_sel2_ok:
    s_lshl2_add_u32 s26, s2, s35
    s_cmp_lg_u32 s26, 1016
    s_cbranch_scc1 L_clr
    s_mov_b32 s60, 1048576
L_ep:
    s_mov_b32 s26, 6881280
    buffer_load_dword v24, v219, s[8:11], s26 offen sc1
    s_mov_b32 s26, 6889472
    buffer_load_dword v25, v219, s[8:11], s26 offen sc1
    s_mov_b32 s26, 6897664
    buffer_load_dword v26, v219, s[8:11], s26 offen sc1
    s_mov_b32 s26, 6905856
    buffer_load_dword v27, v219, s[8:11], s26 offen sc1
    s_sub_u32 s60, s60, 1
    s_cbranch_scc1 L_exit
    s_waitcnt vmcnt(0)
    v_xor_b32 v24, s30, v24
    v_bitop3_b32 v24, v24, v25, s30 bitop3:0xf6
    v_bitop3_b32 v24, v24, v26, s30 bitop3:0xf6
    v_bitop3_b32 v24, v24, v27, s30 bitop3:0xf6
    v_cmp_ne_u32 vcc, 0, v24
    s_cbranch_vccnz L_ep
    s_mov_b32 s26, 6856704
    v_mov_b32 v5, s30
    s_mov_b64 exec, 1
    buffer_store_dword v5, v9, s[8:11], s26 offen sc1
    s_mov_b64 exec, -1
L_clr:
    s_lshl1_add_u32 s26, s58, s35
    s_lshl_b32 s26, s26, 8
    s_add_u32 s26, s26, 6946816
    s_mov_b64 exec, 3
    buffer_atomic_or v9, v219, s[8:11], s26 offen sc1
    s_mov_b64 exec, -1
    buffer_store_dwordx4 v[28:31], v1, s[8:11], s59 offen sc1
    s_add_u32 s59, s59, 32768
    buffer_store_dwordx4 v[28:31], v1, s[8:11], s59 offen sc1
    s_add_u32 s59, s59, 32768
    buffer_store_dwordx4 v[28:31], v1, s[8:11], s59 offen sc1
    s_add_u32 s59, s59, 32768
    buffer_store_dwordx4 v[28:31], v1, s[8:11], s59 offen sc1
    s_add_u32 s59, s59, 32768
    v_mov_b32 v12, 1
L_updA:
    s_and_b32 s53, s31, 3
    s_mul_i32 s53, s53, 224
    s_lshl_b32 s57, s35, 2
    s_lshr_b32 s26, s53, 6
    s_lshl_b32 s26, s26, 7
    s_add_u32 s62, s26, 6979584
L_upd:
    v_readlane_b32 s52, v20, s57
    s_andn2_b32 s54, 0x7ff, s52
    s_lshr_b32 s26, s54, 5
    s_cmp_lg_u32 s26, s58
    s_cbranch_scc1 L_updn
    s_mov_b32 s60, 1048576
    s_mov_b32 exec_lo, 0x0fffffff
    s_mov_b32 exec_hi, 0x0fffffff
L_yfl:
    v_mov_b32 v24, 0
    v_mov_b32 v25, 0
    buffer_atomic_or v24, v220, s[8:11], s62 offen sc0 sc1
    buffer_atomic_or v25, v220, s[8:11], s62 offen offset:256 sc0 sc1
    s_waitcnt vmcnt(0)
    v_xor_b32 v24, s30, v24
    v_bitop3_b32 v24, v24, v25, s30 bitop3:0xf6
    v_cmp_ne_u32 vcc, 0, v24
    s_mov_b64 s[28:29], exec
    s_mov_b64 exec, 1
    ds_add_u32 v14, v12 offset:24
    v_mov_b32 v12, 0
    s_mov_b64 exec, s[28:29]
    s_cbranch_vccz L_yok
    s_sleep 3
    s_sub_u32 s60, s60, 1
    s_cbranch_scc0 L_yfl
    s_endpgm
L_yok:
    v_mul_u32_u24 v4, 200704, v33
    v_lshl_add_u32 v4, v32, 4, v4
    s_mul_i32 s26, s57, 1792
    s_lshl1_add_u32 s26, s53, s26
    s_add_u32 s26, s26, 7077888
    buffer_load_dwordx4 v[40:43], v4, s[8:11], s26 offen sc1
    s_add_u32 s26, s26, 14336
    buffer_load_dwordx4 v[44:47], v4, s[8:11], s26 offen sc1
    s_add_u32 s26, s26, 14336
    buffer_load_dwordx4 v[48:51], v4, s[8:11], s26 offen sc1
    s_add_u32 s26, s26, 14336
    buffer_load_dwordx4 v[52:55], v4, s[8:11], s26 offen sc1
    s_add_u32 s26, s26, 14336
    buffer_load_dwordx4 v[56:59], v4, s[8:11], s26 offen sc1
    s_add_u32 s26, s26, 14336
    buffer_load_dwordx4 v[60:63], v4, s[8:11], s26 offen sc1
    s_add_u32 s26, s26, 14336
    buffer_load_dwordx4 v[64:67], v4, s[8:11], s26 offen sc1
    s_add_u32 s26, s26, 14336
    buffer_load_dwordx4 v[68:71], v4, s[8:11], s26 offen sc1
    s_add_u32 s26, s26, 14336
    buffer_load_dwordx4 v[72:75], v4, s[8:11], s26 offen sc1
    s_add_u32 s26, s26, 14336
    buffer_load_dwordx4 v[76:79], v4, s[8:11], s26 offen sc1
    s_add_u32 s26, s26, 14336
    buffer_load_dwordx4 v[80:83], v4, s[8:11], s26 offen sc1
    s_add_u32 s26, s26, 14336
    buffer_load_dwordx4 v[84:87], v4, s[8:11], s26 offen sc1
    s_add_u32 s26, s26, 14336
    buffer_load_dwordx4 v[88:91], v4, s[8:11], s26 offen sc1
    s_add_u32 s26, s26, 14336
    buffer_load_dwordx4 v[92:95], v4, s[8:11], s26 offen sc1
    s_add_u32 s26, s26, 14336
    s_mov_b64 exec, -1
    s_lshr_b32 s26, s52, 11
    s_not_b32 s55, s26
    s_and_b32 s29, s26, 0x7fff
    s_bitcmp1_b32 s26, 15
    s_cselect_b32 s26, s29, s55
    s_lshl_b32 s26, s26, 16
    v_mov_b32 v6, 0xbfb8aa3b
    v_mul_f32 v6, s26, v6
    v_exp_f32 v6, v6
    s_nop 0
    v_add_f32 v6, 1.0, v6
    v_rcp_f32 v6, v6
    s_nop 0
    v_cvt_pk_bf16_f32 v6, v6, v6
    v_lshlrev_b32 v6, 16, v6
    s_mul_i32 s26, s57, 448
    s_add_u32 s26, s26, 159744
    v_lshl_add_u32 v7, v32, 4, s26
    s_waitcnt vmcnt(0)
    v_pk_add_f32 v[40:41], v[40:41], v[44:45]
    v_pk_add_f32 v[42:43], v[42:43], v[46:47]
    v_pk_add_f32 v[40:41], v[40:41], v[48:49]
    v_pk_add_f32 v[42:43], v[42:43], v[50:51]
    v_pk_add_f32 v[40:41], v[40:41], v[52:53]
    v_pk_add_f32 v[42:43], v[42:43], v[54:55]
    v_pk_add_f32 v[40:41], v[40:41], v[56:57]
    v_pk_add_f32 v[42:43], v[42:43], v[58:59]
    v_pk_add_f32 v[40:41], v[40:41], v[60:61]
    v_pk_add_f32 v[42:43], v[42:43], v[62:63]
    v_pk_add_f32 v[40:41], v[40:41], v[64:65]
    v_pk_add_f32 v[42:43], v[42:43], v[66:67]
    v_pk_add_f32 v[40:41], v[40:41], v[68:69]
    v_pk_add_f32 v[42:43], v[42:43], v[70:71]
    v_pk_add_f32 v[40:41], v[40:41], v[72:73]
    v_pk_add_f32 v[42:43], v[42:43], v[74:75]
    v_pk_add_f32 v[40:41], v[40:41], v[76:77]
    v_pk_add_f32 v[42:43], v[42:43], v[78:79]
    v_pk_add_f32 v[40:41], v[40:41], v[80:81]
    v_pk_add_f32 v[42:43], v[42:43], v[82:83]
    v_pk_add_f32 v[40:41], v[40:41], v[84:85]
    v_pk_add_f32 v[42:43], v[42:43], v[86:87]
    v_pk_add_f32 v[40:41], v[40:41], v[88:89]
    v_pk_add_f32 v[42:43], v[42:43], v[90:91]
    v_pk_add_f32 v[40:41], v[40:41], v[92:93]
    v_pk_add_f32 v[42:43], v[42:43], v[94:95]
    v_mov_b32 v44, v40
    v_mov_b32 v45, v41
    v_mov_b32 v46, v42
    v_mov_b32 v47, v43
    v_permlane32_swap_b32 v40, v44
    v_permlane32_swap_b32 v41, v45
    v_permlane32_swap_b32 v42, v46
    v_permlane32_swap_b32 v43, v47
    v_add_f32 v40, v40, v44
    v_add_f32 v41, v41, v45
    v_add_f32 v42, v42, v46
    v_add_f32 v43, v43, v47
    v_cvt_pk_bf16_f32 v40, v40, v41
    v_and_b32 v41, 0xffff0000, v40
    v_lshlrev_b32 v40, 16, v40
    v_mul_f32 v40, v40, v6
    v_mul_f32 v41, v41, v6
    v_cvt_pk_bf16_f32 v40, v40, v41
    v_and_b32 v41, 0xffff0000, v40
    v_lshlrev_b32 v40, 16, v40
    v_cvt_pk_bf16_f32 v42, v42, v43
    v_and_b32 v43, 0xffff0000, v42
    v_lshlrev_b32 v42, 16, v42
    v_mul_f32 v42, v42, v6
    v_mul_f32 v43, v43, v6
    v_cvt_pk_bf16_f32 v42, v42, v43
    v_and_b32 v43, 0xffff0000, v42
    v_lshlrev_b32 v42, 16, v42
    s_and_b32 s54, s54, 31
    v_mov_b32 v5, s57
    s_lshl_b32 s26, s54, 2
    s_add_u32 s26, s26, 163328
    v_mov_b32 v4, s26
    s_mov_b64 exec, 0x0fffffff
    ds_write_b128 v7, v[40:43]
    s_mov_b64 exec, 1
    ds_write_b32 v4, v5
    s_mov_b64 exec, -1
L_updn:
    s_add_u32 s57, s57, 1
    s_and_b32 s26, s57, 3
    s_cbranch_scc1 L_upd
    v_mov_b32 v6, 512
    s_mov_b64 exec, 1
    ds_add_u32 v14, v6 offset:28
    s_mov_b64 exec, -1
    s_branch L_wo1
L_svcB:
    v_add_u32 v4, 0, v3
    v_mul_u32_u24 v5, 4682, v4
    v_lshrrev_b32 v5, 16, v5
    v_mul_u32_u24 v5, 672, v5
    v_lshl_add_u32 v200, v4, 4, v5
    v_add_u32 v4, 64, v3
    v_mul_u32_u24 v5, 4682, v4
    v_lshrrev_b32 v5, 16, v5
    v_mul_u32_u24 v5, 672, v5
    v_lshl_add_u32 v201, v4, 4, v5
    v_add_u32 v4, 128, v3
    v_mul_u32_u24 v5, 4682, v4
    v_lshrrev_b32 v5, 16, v5
    v_mul_u32_u24 v5, 672, v5
    v_lshl_add_u32 v202, v4, 4, v5
    v_add_u32 v4, 192, v3
    v_mul_u32_u24 v5, 4682, v4
    v_lshrrev_b32 v5, 16, v5
    v_mul_u32_u24 v5, 672, v5
    v_lshl_add_u32 v203, v4, 4, v5
    v_add_u32 v4, 256, v3
    v_mul_u32_u24 v5, 4682, v4
    v_lshrrev_b32 v5, 16, v5
    v_mul_u32_u24 v5, 672, v5
    v_lshl_add_u32 v204, v4, 4, v5
    v_add_u32 v4, 320, v3
    v_mul_u32_u24 v5, 4682, v4
    v_lshrrev_b32 v5, 16, v5
    v_mul_u32_u24 v5, 672, v5
    v_lshl_add_u32 v205, v4, 4, v5
    v_add_u32 v4, 384, v3
    v_mul_u32_u24 v5, 4682, v4
    v_lshrrev_b32 v5, 16, v5
    v_mul_u32_u24 v5, 672, v5
    v_lshl_add_u32 v206, v4, 4, v5
    v_mov_b32 v16, 0
    v_mov_b32 v17, 0
    v_mov_b32 v18, 0
    v_mov_b32 v19, 0
    v_add_u32 v209, 100352, v1
    v_bfe_u32 v7, v3, 2, 2
    v_lshl_add_u32 v5, v33, 3, v7
    v_lshlrev_b32 v5, 7, v5
    v_bfe_u32 v4, v3, 4, 1
    v_lshl_add_u32 v5, v4, 5, v5
    v_and_b32 v4, 3, v3
    v_lshl_add_u32 v5, v4, 3, v5
    v_lshrrev_b32 v7, 1, v7
    v_xor_b32 v7, s35, v7
    v_and_b32 v7, 1, v7
    v_lshl_add_u32 v5, v7, 6, v5
    v_add_u32 v210, 151552, v5
    v_lshlrev_b32 v4, 4, v217
    v_lshl_add_u32 v4, v33, 4, v4
    v_add_u32 v218, 101376, v4
    v_mul_u32_u24 v215, 7168, v33
    v_lshl_add_u32 v215, v32, 2, v215
    v_add_u32 v216, 3584, v215
    s_cmp_eq_u32 s35, 2
    s_cbranch_scc1 L_svcB2
    v_lshrrev_b32 v4, 4, v3
    v_and_b32 v5, 15, v3
    v_lshlrev_b32 v5, 2, v5
    v_lshl_add_u32 v221, v4, 9, v5
    v_lshl_add_u32 v222, v4, 5, v14
    v_and_b32 v223, 48, v3
    v_and_b32 v5, 15, v3
    v_add_u32 v6, v5, v4
    v_mul_u32_u24 v224, 286720, v6
    v_add_u32 v224, 1, v224
    v_bfm_b32 v225, v5, 0
    s_mul_i32 s26, s31, 28
    s_add_u32 s28, s26, 27
    s_xor_b32 s26, s26, s28
    s_mov_b32 s62, 0x55555555
    s_cmp_ge_u32 s26, 64
    s_cselect_b32 s62, -1, s62
    s_mov_b32 s63, s62
    s_lshr_b32 s28, s32, 2
    s_lshl4_add_u32 s26, s31, s28
    s_lshl_b32 s26, s26, 7
    s_add_u32 s26, s26, 6914048
    s_mov_b32 s60, 1048576
Lsp_36:
    ds_read_b32 v8, v14 offset:20
    s_waitcnt lgkmcnt(0)
    v_readfirstlane_b32 s61, v8
    s_cmp_ge_u32 s61, 1
    s_cbranch_scc1 Lsd_37
    s_sleep 1
    s_sub_u32 s60, s60, 1
    s_cbranch_scc0 Lsp_36
    s_endpgm
Lsd_37:
    s_mov_b32 s60, 1048576
    s_mov_b32 s52, 0x11111111
    s_mov_b32 s53, 0x11111111
    s_mov_b64 s[56:57], s[52:53]
    s_mov_b64 exec, s[62:63]
    v_mov_b32 v28, 0
    buffer_atomic_or v28, v221, s[8:11], s26 offen sc0 sc1
    s_sleep 3
    v_mov_b32 v29, 0
    buffer_atomic_or v29, v221, s[8:11], s26 offen sc0 sc1
    s_sleep 3
    v_mov_b32 v30, 0
    buffer_atomic_or v30, v221, s[8:11], s26 offen sc0 sc1
    s_sleep 3
L_kv:
    v_mov_b32 v31, 0
    buffer_atomic_or v31, v221, s[8:11], s26 offen sc0 sc1
    s_waitcnt vmcnt(3)
    v_cmp_ne_u32 vcc, s30, v28
    s_lshr_b64 s[28:29], vcc, 1
    s_or_b64 s[28:29], s[28:29], vcc
    s_andn2_b64 s[54:55], s[56:57], s[28:29]
    s_cbranch_scc0 L_kvs0
    s_ff1_i32_b64 s54, s[54:55]
    s_lshl_b64 exec, 1, s54
    ds_write_b32 v14, v224 offset:88
    s_mov_b64 exec, s[62:63]
    s_mov_b64 s[56:57], 0
L_kvs0:
    s_lshr_b64 s[54:55], s[28:29], 2
    s_or_b64 s[28:29], s[28:29], s[54:55]
    s_andn2_b64 s[28:29], s[52:53], s[28:29]
    s_cbranch_scc0 L_kvn0
    s_andn2_b64 s[52:53], s[52:53], s[28:29]
    v_lshrrev_b64 v[4:5], v223, s[28:29]
    v_and_b32 v5, v225, v4
    v_bcnt_u32_b32 v5, v5, 0
    v_lshl_add_u32 v5, v5, 2, v222
    s_mov_b64 exec, s[28:29]
    ds_write_b32 v5, v224 offset:64
    s_mov_b64 exec, s[62:63]
    v_and_b32 v4, 0xffff, v4
    v_bcnt_u32_b32 v4, v4, 0
    v_lshl_add_u32 v222, v4, 2, v222
    s_cmp_eq_u64 s[52:53], 0
    s_cbranch_scc1 L_kvdone
L_kvn0:
    v_mov_b32 v28, 0
    buffer_atomic_or v28, v221, s[8:11], s26 offen sc0 sc1
    s_waitcnt vmcnt(3)
    v_cmp_ne_u32 vcc, s30, v29
    s_lshr_b64 s[28:29], vcc, 1
    s_or_b64 s[28:29], s[28:29], vcc
    s_andn2_b64 s[54:55], s[56:57], s[28:29]
    s_cbranch_scc0 L_kvs1
    s_ff1_i32_b64 s54, s[54:55]
    s_lshl_b64 exec, 1, s54
    ds_write_b32 v14, v224 offset:88
    s_mov_b64 exec, s[62:63]
    s_mov_b64 s[56:57], 0
L_kvs1:
    s_lshr_b64 s[54:55], s[28:29], 2
    s_or_b64 s[28:29], s[28:29], s[54:55]
    s_andn2_b64 s[28:29], s[52:53], s[28:29]
    s_cbranch_scc0 L_kvn1
    s_andn2_b64 s[52:53], s[52:53], s[28:29]
    v_lshrrev_b64 v[4:5], v223, s[28:29]
    v_and_b32 v5, v225, v4
    v_bcnt_u32_b32 v5, v5, 0
    v_lshl_add_u32 v5, v5, 2, v222
    s_mov_b64 exec, s[28:29]
    ds_write_b32 v5, v224 offset:64
    s_mov_b64 exec, s[62:63]
    v_and_b32 v4, 0xffff, v4
    v_bcnt_u32_b32 v4, v4, 0
    v_lshl_add_u32 v222, v4, 2, v222
    s_cmp_eq_u64 s[52:53], 0
    s_cbranch_scc1 L_kvdone
L_kvn1:
    v_mov_b32 v29, 0
    buffer_atomic_or v29, v221, s[8:11], s26 offen sc0 sc1
    s_waitcnt vmcnt(3)
    v_cmp_ne_u32 vcc, s30, v30
    s_lshr_b64 s[28:29], vcc, 1
    s_or_b64 s[28:29], s[28:29], vcc
    s_andn2_b64 s[54:55], s[56:57], s[28:29]
    s_cbranch_scc0 L_kvs2
    s_ff1_i32_b64 s54, s[54:55]
    s_lshl_b64 exec, 1, s54
    ds_write_b32 v14, v224 offset:88
    s_mov_b64 exec, s[62:63]
    s_mov_b64 s[56:57], 0
L_kvs2:
    s_lshr_b64 s[54:55], s[28:29], 2
    s_or_b64 s[28:29], s[28:29], s[54:55]
    s_andn2_b64 s[28:29], s[52:53], s[28:29]
    s_cbranch_scc0 L_kvn2
    s_andn2_b64 s[52:53], s[52:53], s[28:29]
    v_lshrrev_b64 v[4:5], v223, s[28:29]
    v_and_b32 v5, v225, v4
    v_bcnt_u32_b32 v5, v5, 0
    v_lshl_add_u32 v5, v5, 2, v222
    s_mov_b64 exec, s[28:29]
    ds_write_b32 v5, v224 offset:64
    s_mov_b64 exec, s[62:63]
    v_and_b32 v4, 0xffff, v4
    v_bcnt_u32_b32 v4, v4, 0
    v_lshl_add_u32 v222, v4, 2, v222
    s_cmp_eq_u64 s[52:53], 0
    s_cbranch_scc1 L_kvdone
L_kvn2:
    v_mov_b32 v30, 0
    buffer_atomic_or v30, v221, s[8:11], s26 offen sc0 sc1
    s_waitcnt vmcnt(3)
    v_cmp_ne_u32 vcc, s30, v31
    s_lshr_b64 s[28:29], vcc, 1
    s_or_b64 s[28:29], s[28:29], vcc
    s_andn2_b64 s[54:55], s[56:57], s[28:29]
    s_cbranch_scc0 L_kvs3
    s_ff1_i32_b64 s54, s[54:55]
    s_lshl_b64 exec, 1, s54
    ds_write_b32 v14, v224 offset:88
    s_mov_b64 exec, s[62:63]
    s_mov_b64 s[56:57], 0
L_kvs3:
    s_lshr_b64 s[54:55], s[28:29], 2
    s_or_b64 s[28:29], s[28:29], s[54:55]
    s_andn2_b64 s[28:29], s[52:53], s[28:29]
    s_cbranch_scc0 L_kvn3
    s_andn2_b64 s[52:53], s[52:53], s[28:29]
    v_lshrrev_b64 v[4:5], v223, s[28:29]
    v_and_b32 v5, v225, v4
    v_bcnt_u32_b32 v5, v5, 0
    v_lshl_add_u32 v5, v5, 2, v222
    s_mov_b64 exec, s[28:29]
    ds_write_b32 v5, v224 offset:64
    s_mov_b64 exec, s[62:63]
    v_and_b32 v4, 0xffff, v4
    v_bcnt_u32_b32 v4, v4, 0
    v_lshl_add_u32 v222, v4, 2, v222
    s_cmp_eq_u64 s[52:53], 0
    s_cbranch_scc1 L_kvdone
L_kvn3:
    s_sub_u32 s60, s60, 1
    s_cbranch_scc0 L_kv
    s_endpgm
L_kvdone:
    s_mov_b64 exec, -1
L_svcB2:
    s_mov_b32 s16, s38
    s_mov_b32 s17, s39
    s_mov_b32 s18, 0x62000
    s_mov_b32 s19, 0x20000
    s_and_b32 s53, s31, 3
    s_mul_i32 s53, s53, 224
    s_and_b32 s27, s35, 1
    s_mul_i32 s55, s27, 7168
    s_mul_i32 s57, s27, 28672
    s_add_u32 s57, s57, s53
    s_mov_b32 s60, 1048576
Lsp_38:
    ds_read_b32 v8, v14 offset:92
    s_waitcnt lgkmcnt(0)
    v_readfirstlane_b32 s61, v8
    s_cmp_ge_u32 s61, 256
    s_cbranch_scc1 Lsd_39
    s_sleep 4
    s_sub_u32 s60, s60, 1
    s_cbranch_scc0 Lsp_38
    s_endpgm
Lsd_39:
    ds_write_b128 v209, v[16:19]
    s_mov_b64 exec, 1
    ds_add_u32 v14, v15 offset:32
    s_mov_b64 exec, -1
    s_cmp_lg_u32 s35, 2
    s_cbranch_scc1 L_nofl
    s_lshl_b32 s26, s2, 7
    s_add_u32 s26, s26, 6881280
    v_mov_b32 v5, s30
    s_mov_b64 exec, 1
    buffer_store_dword v5, v9, s[8:11], s26 offen sc1
    s_mov_b64 exec, -1
L_nofl:
    s_cmp_lt_u32 s2, 196
    s_cbranch_scc1 L_st2w
    s_branch L_wo1
L_st3:
    s_mov_b32 s60, 1048576
Lsp_40:
    ds_read_b32 v8, v14 offset:16
    s_waitcnt lgkmcnt(0)
    v_readfirstlane_b32 s61, v8
    s_cmp_ge_u32 s61, 4
    s_cbranch_scc1 Lsd_41
    s_sleep 1
    s_sub_u32 s60, s60, 1
    s_cbranch_scc0 Lsp_40
    s_endpgm
Lsd_41:
    ds_read_b64_tr_b16 v[120:121], v210 offset:0
    ds_read_b64_tr_b16 v[122:123], v210 offset:512
    ds_read_b64_tr_b16 v[124:125], v210 offset:2048
    ds_read_b64_tr_b16 v[126:127], v210 offset:2560
    ds_read_b64_tr_b16 v[128:129], v210 offset:4096
    ds_read_b64_tr_b16 v[130:131], v210 offset:4608
    ds_read_b64_tr_b16 v[132:133], v210 offset:6144
    ds_read_b64_tr_b16 v[134:135], v210 offset:6656
    ds_read_b128 v[40:43], v218 offset:0
    s_waitcnt lgkmcnt(0)
    v_mfma_f32_32x32x16_bf16 v[104:119], v[40:43], v[120:123], 0
    ds_read_b128 v[44:47], v218 offset:32
    s_waitcnt lgkmcnt(0)
    v_mfma_f32_32x32x16_bf16 v[104:119], v[44:47], v[124:127], v[104:119]
    ds_read_b128 v[48:51], v218 offset:64
    s_waitcnt lgkmcnt(0)
    v_mfma_f32_32x32x16_bf16 v[104:119], v[48:51], v[128:131], v[104:119]
    ds_read_b128 v[52:55], v218 offset:96
    s_waitcnt lgkmcnt(0)
    v_mfma_f32_32x32x16_bf16 v[104:119], v[52:55], v[132:135], v[104:119]
    s_mul_i32 s26, s66, 14336
    s_lshl1_add_u32 s28, s67, s27
    s_lshl_b32 s29, s28, 7
    s_add_u32 s26, s26, s29
    s_add_u32 s26, s26, 7077888
    s_lshl2_add_u32 s28, s66, s29
    s_add_u32 s28, s28, 6979584
    s_nop 4
    buffer_store_dword v104, v215, s[8:11], s26 offen sc1
    buffer_store_dword v105, v215, s[8:11], s26 offen offset:1792 sc1
    buffer_store_dword v106, v216, s[8:11], s26 offen sc1
    buffer_store_dword v107, v216, s[8:11], s26 offen offset:1792 sc1
    s_waitcnt vmcnt(0)
    v_mov_b32 v5, s30
    s_mov_b64 exec, 1
    buffer_atomic_swap v5, v9, s[8:11], s28 offen sc1
    s_mov_b64 exec, -1
L_wo1:
    s_mov_b32 s16, s38
    s_mov_b32 s17, s39
    s_mov_b32 s18, 0x62000
    s_mov_b32 s19, 0x20000
    s_mov_b32 s27, 0
    s_mov_b32 s60, 1048576
Lsp_42:
    ds_read_b32 v8, v14 offset:124
    s_waitcnt lgkmcnt(0)
    v_readfirstlane_b32 s61, v8
    s_cmp_ge_u32 s61, 128
    s_cbranch_scc1 Lsd_43
    s_sleep 4
    s_sub_u32 s60, s60, 1
    s_cbranch_scc0 Lsp_42
    s_endpgm
Lsd_43:
L_wo:
    s_mov_b64 exec, 1
    ds_add_rtn_u32 v8, v14, v15 offset:120
    s_mov_b64 exec, -1
    s_waitcnt lgkmcnt(0)
    v_readfirstlane_b32 s26, v8
    s_cmp_ge_u32 s26, 14
    s_cbranch_scc1 L_wodone
    s_add_u32 s27, s27, 1
    s_mul_i32 s55, s26, 7168
    s_mul_i32 s57, s26, 28672
    s_add_u32 s57, s57, s53
    s_add_u32 m0, s55, 0
    s_waitcnt vmcnt(14)
    buffer_load_dwordx4 v200, s[16:19], s57 offen lds
    s_add_u32 m0, s55, 1024
    s_waitcnt vmcnt(14)
    buffer_load_dwordx4 v201, s[16:19], s57 offen lds
    s_add_u32 m0, s55, 2048
    s_waitcnt vmcnt(14)
    buffer_load_dwordx4 v202, s[16:19], s57 offen lds
    s_add_u32 m0, s55, 3072
    s_waitcnt vmcnt(14)
    buffer_load_dwordx4 v203, s[16:19], s57 offen lds
    s_add_u32 m0, s55, 4096
    s_waitcnt vmcnt(14)
    buffer_load_dwordx4 v204, s[16:19], s57 offen lds
    s_add_u32 m0, s55, 5120
    s_waitcnt vmcnt(14)
    buffer_load_dwordx4 v205, s[16:19], s57 offen lds
    s_add_u32 m0, s55, 6144
    s_waitcnt vmcnt(14)
    buffer_load_dwordx4 v206, s[16:19], s57 offen lds
    s_waitcnt vmcnt(7)
    s_mov_b64 exec, 1
    ds_add_u32 v14, v12 offset:24
    v_mov_b32 v12, 0
    s_branch L_wo
L_wodone:
    v_mov_b32 v5, s27
    s_waitcnt vmcnt(0)
    s_mov_b64 exec, 1
    ds_add_u32 v14, v12 offset:24
    s_mov_b64 exec, -1
    s_mov_b64 exec, 1
    ds_add_u32 v14, v5 offset:32
    s_mov_b64 exec, -1
L_ofetch:
    s_waitcnt vmcnt(0) lgkmcnt(0)
L_exit:
L_code_end:
    s_endpgm
.section .rodata,"a"
.p2align 6
.amdhsa_kernel gated_mix__softmax_full_mha__moe_arch_mod__prompt_kernel
  .amdhsa_next_free_vgpr 256
  .amdhsa_next_free_sgpr 102
  .amdhsa_accum_offset 256
  .amdhsa_group_segment_fixed_size 0
  .amdhsa_kernarg_size 96
  .amdhsa_user_sgpr_count 2
  .amdhsa_user_sgpr_kernarg_segment_ptr 1
  .amdhsa_system_sgpr_workgroup_id_x 1
  .amdhsa_float_denorm_mode_32 3
.end_amdhsa_kernel
```
